```python
import torch

def _softmax(x, axis=-1):
    return torch.softmax(x, dim=axis)

def _gelu(x):
    return torch.nn.functional.gelu(x, approximate='tanh')

def _silu(x):
    return torch.nn.functional.silu(x)

def _sigmoid(x):
    return torch.sigmoid(x)

def _layernorm(x, axis=-1, eps=1e-05):
    m = x.mean(dim=axis, keepdim=True)
    v = x.var(dim=axis, keepdim=True, unbiased=False)
    return (x - m) / torch.sqrt(v + eps)

def _scatter_add(tgt, idx, src, axis=0):
    return tgt.clone().index_add_(axis, idx, src)

def _segment_sum(src, seg, n):
    out = torch.zeros((n,) + src.shape[1:], dtype=src.dtype)
    return out.index_add_(0, seg, src)

def _pad(x, pw):
    flat = tuple((v for pair in reversed(pw) for v in pair))
    return torch.nn.functional.pad(x, flat)
kernel_name = 'adaLN_cond__linear_kernel_hedgehog__geglu_ffn__prompt'

def setup_inputs():

    _w = lambda a: (lambda t: t.to(torch.bfloat16) if t.is_floating_point() else t)(torch.as_tensor(a))

    def _A_setup():
        B, S, D, H = (1, 2048, 640, 32)
        Dh = D // H
        return {'x': _w((lambda *s: torch.randn(*s, dtype=torch.bfloat16) * 0.05)(B, S, D)), 'wqkv': _w((lambda *s: torch.randn(*s, dtype=torch.bfloat16) * 0.4)(D, 3 * D)), 'w_phi': _w((lambda *s: torch.randn(*s, dtype=torch.bfloat16) * 0.4)(H, Dh, Dh) * Dh ** (-0.5)), 'wo': _w((lambda *s: torch.randn(*s, dtype=torch.bfloat16) * 0.05)(D, D))}
    _A_in = _A_setup()

    def _B_setup():
        B, S, D, F = (1, 2048, 640, 1728)
        return {'x': _w((lambda *s: torch.randn(*s, dtype=torch.bfloat16) * 0.05)(B, S, D)), 'w_gate': _w((lambda *s: torch.randn(*s, dtype=torch.bfloat16) * 0.05)(D, F)), 'w_up': _w((lambda *s: torch.randn(*s, dtype=torch.bfloat16) * 0.05)(D, F)), 'w_down': _w((lambda *s: torch.randn(*s, dtype=torch.bfloat16) * 0.05)(F, D))}
    _B_in = _B_setup()
    return {'A_x': _A_in['x'], 'A_wqkv': _A_in['wqkv'], 'A_w_phi': _A_in['w_phi'], 'A_wo': _A_in['wo'], 'B_x': _B_in['x'], 'B_w_gate': _B_in['w_gate'], 'B_w_up': _B_in['w_up'], 'B_w_down': _B_in['w_down'], 'c': _w((lambda *s: torch.randn(*s, dtype=torch.bfloat16) * 0.1)(1, 640) * 8.0), 'w_mod': _w((lambda *s: torch.randn(*s, dtype=torch.bfloat16) * 0.1)(640, 6 * 640) * 640 ** (-0.5) * 8.0)}

def reference(A_x, A_wqkv, A_w_phi, A_wo, B_x, B_w_gate, B_w_up, B_w_down, c, w_mod):

    def _A_ref(x, wqkv, w_phi, wo):
        B, S, D = x.shape
        H = 32
        Dh = D // H
        qkv = (lambda x, *d: x.permute(*d))((x @ wqkv).reshape(B, S, 3, H, Dh), 2, 0, 3, 1, 4)
        q, k, v = (qkv[0], qkv[1], qkv[2])
        pq = torch.einsum('bhsd,hdf->bhsf', q, w_phi)
        pk = torch.einsum('bhsd,hdf->bhsf', k, w_phi)
        phi_q = torch.concatenate([_softmax(pq, axis=-1), _softmax(-pq, axis=-1)], axis=-1)
        phi_k = torch.concatenate([_softmax(pk, axis=-1), _softmax(-pk, axis=-1)], axis=-1)
        kv = torch.einsum('bhsf,bhsd->bhfd', phi_k, v)
        z = torch.einsum('bhsf->bhf', phi_k)
        num = torch.einsum('bhqf,bhfd->bhqd', phi_q, kv)
        den = torch.einsum('bhqf,bhf->bhq', phi_q, z)[..., None] + 1e-06
        o = num / den
        return (lambda x, *d: x.permute(*d))(o, 0, 2, 1, 3).reshape(B, S, D) @ wo

    def _B_ref(x, w_gate, w_up, w_down):
        return _gelu(x @ w_gate) * (x @ w_up) @ w_down
    x = A_x
    mod = (_silu(c) @ w_mod).reshape(c.shape[0], 6, 1, -1)
    sa, ca, ga, sb, cb, gb = (mod[:, 0].clone(), mod[:, 1].clone(), mod[:, 2].clone(), mod[:, 3].clone(), mod[:, 4].clone(), mod[:, 5].clone())
    h = _layernorm(x, axis=-1) * (1 + ca) + sa
    x = x + ga * _A_ref(h, A_wqkv, A_w_phi, A_wo)
    h = _layernorm(x, axis=-1) * (1 + cb) + sb
    x = x + gb * _B_ref(h, B_w_gate, B_w_up, B_w_down)
    return x
```

```asm
; @launch kernel=k1_kernel grid=(477,1,1) block=(256,1,1) lds=24576
; @launch kernel=mega_kernel grid=(256,1,1) block=(512,1,1) lds=163840
.amdgcn_target "amdgcn-amd-amdhsa--gfx950"
.text
.globl k1_kernel
.p2align 8
.type k1_kernel,@function
k1_kernel:
    s_cmp_ge_u32 s2, 477
    s_cbranch_scc1 L1_end
    s_cmp_ge_u32 s2, 236
    s_cbranch_scc0 L1_notmod
    s_load_dwordx2 s[4:5], s[0:1], 72
    s_load_dwordx2 s[8:9], s[0:1], 64
    s_load_dwordx2 s[12:13], s[0:1], 96
    s_mov_b32 s6, 4915200
    s_mov_b32 s7, 0x20000
    s_mov_b32 s10, 1280
    s_mov_b32 s11, 0x20000
    s_mov_b32 s14, 268435456
    s_mov_b32 s15, 0x20000
    s_cmp_eq_u32 s2, 476
    s_cbranch_scc1 L1_zero
    s_sub_u32 s23, s2, 236
    s_mul_i32 s24, s23, 1093
    s_lshr_b32 s24, s24, 16
    s_mul_i32 s25, s24, 60
    s_sub_u32 s25, s23, s25
    v_and_b32 v1, 7, v0
    v_lshrrev_b32 v2, 3, v0
    v_mul_u32_u24 v3, 7680, v2
    v_lshl_add_u32 v3, v1, 4, v3
    v_lshlrev_b32 v4, 1, v2
    s_mul_i32 s26, s24, 1228800
    s_lshl_b32 s27, s25, 7
    s_add_u32 s26, s26, s27
    s_mul_i32 s27, s24, 320
    s_waitcnt lgkmcnt(0)
    buffer_load_ushort v10, v4, s[8:11], s27 offen offset:0
    buffer_load_ushort v11, v4, s[8:11], s27 offen offset:64
    buffer_load_ushort v12, v4, s[8:11], s27 offen offset:128
    buffer_load_ushort v13, v4, s[8:11], s27 offen offset:192
    buffer_load_ushort v14, v4, s[8:11], s27 offen offset:256
    buffer_load_dwordx4 v[16:19], v3, s[4:7], s26 offen
    s_add_u32 s26, s26, 245760
    buffer_load_dwordx4 v[20:23], v3, s[4:7], s26 offen
    s_add_u32 s26, s26, 245760
    buffer_load_dwordx4 v[24:27], v3, s[4:7], s26 offen
    s_add_u32 s26, s26, 245760
    buffer_load_dwordx4 v[28:31], v3, s[4:7], s26 offen
    s_add_u32 s26, s26, 245760
    buffer_load_dwordx4 v[32:35], v3, s[4:7], s26 offen
    v_mov_b32 v40, 0
    v_mov_b32 v41, 0
    v_mov_b32 v42, 0
    v_mov_b32 v43, 0
    v_mov_b32 v44, 0
    v_mov_b32 v45, 0
    v_mov_b32 v46, 0
    v_mov_b32 v47, 0
    v_lshlrev_b32 v5, 8, v2
    v_lshl_add_u32 v5, v1, 5, v5
    s_waitcnt vmcnt(5)
    v_lshlrev_b32 v10, 16, v10
    v_lshlrev_b32 v11, 16, v11
    v_lshlrev_b32 v12, 16, v12
    v_lshlrev_b32 v13, 16, v13
    v_lshlrev_b32 v14, 16, v14
    v_mul_f32 v50, 0xbfb8aa3b, v10
    v_mul_f32 v51, 0xbfb8aa3b, v11
    v_mul_f32 v52, 0xbfb8aa3b, v12
    v_mul_f32 v53, 0xbfb8aa3b, v13
    v_mul_f32 v54, 0xbfb8aa3b, v14
    v_exp_f32 v50, v50
    v_exp_f32 v51, v51
    v_exp_f32 v52, v52
    v_exp_f32 v53, v53
    v_exp_f32 v54, v54
    v_add_f32 v50, 1.0, v50
    v_add_f32 v51, 1.0, v51
    v_add_f32 v52, 1.0, v52
    v_add_f32 v53, 1.0, v53
    v_add_f32 v54, 1.0, v54
    v_rcp_f32 v50, v50
    v_rcp_f32 v51, v51
    v_rcp_f32 v52, v52
    v_rcp_f32 v53, v53
    v_rcp_f32 v54, v54
    v_mul_f32 v10, v10, v50
    v_mul_f32 v11, v11, v51
    v_mul_f32 v12, v12, v52
    v_mul_f32 v13, v13, v53
    v_mul_f32 v14, v14, v54
    v_cvt_pk_bf16_f32 v10, v10, v10
    v_cvt_pk_bf16_f32 v11, v11, v11
    v_cvt_pk_bf16_f32 v12, v12, v12
    v_cvt_pk_bf16_f32 v13, v13, v13
    v_cvt_pk_bf16_f32 v14, v14, v14
    v_lshlrev_b32 v10, 16, v10
    v_lshlrev_b32 v11, 16, v11
    v_lshlrev_b32 v12, 16, v12
    v_lshlrev_b32 v13, 16, v13
    v_lshlrev_b32 v14, 16, v14
    s_waitcnt vmcnt(4)
    v_lshlrev_b32 v56, 16, v16
    v_and_b32 v57, 0xffff0000, v16
    v_lshlrev_b32 v58, 16, v17
    v_and_b32 v59, 0xffff0000, v17
    v_lshlrev_b32 v60, 16, v18
    v_and_b32 v61, 0xffff0000, v18
    v_lshlrev_b32 v62, 16, v19
    v_and_b32 v63, 0xffff0000, v19
    v_fmac_f32 v40, v56, v10
    v_fmac_f32 v41, v57, v10
    v_fmac_f32 v42, v58, v10
    v_fmac_f32 v43, v59, v10
    v_fmac_f32 v44, v60, v10
    v_fmac_f32 v45, v61, v10
    v_fmac_f32 v46, v62, v10
    v_fmac_f32 v47, v63, v10
    s_waitcnt vmcnt(3)
    v_lshlrev_b32 v56, 16, v20
    v_and_b32 v57, 0xffff0000, v20
    v_lshlrev_b32 v58, 16, v21
    v_and_b32 v59, 0xffff0000, v21
    v_lshlrev_b32 v60, 16, v22
    v_and_b32 v61, 0xffff0000, v22
    v_lshlrev_b32 v62, 16, v23
    v_and_b32 v63, 0xffff0000, v23
    v_fmac_f32 v40, v56, v11
    v_fmac_f32 v41, v57, v11
    v_fmac_f32 v42, v58, v11
    v_fmac_f32 v43, v59, v11
    v_fmac_f32 v44, v60, v11
    v_fmac_f32 v45, v61, v11
    v_fmac_f32 v46, v62, v11
    v_fmac_f32 v47, v63, v11
    s_waitcnt vmcnt(2)
    v_lshlrev_b32 v56, 16, v24
    v_and_b32 v57, 0xffff0000, v24
    v_lshlrev_b32 v58, 16, v25
    v_and_b32 v59, 0xffff0000, v25
    v_lshlrev_b32 v60, 16, v26
    v_and_b32 v61, 0xffff0000, v26
    v_lshlrev_b32 v62, 16, v27
    v_and_b32 v63, 0xffff0000, v27
    v_fmac_f32 v40, v56, v12
    v_fmac_f32 v41, v57, v12
    v_fmac_f32 v42, v58, v12
    v_fmac_f32 v43, v59, v12
    v_fmac_f32 v44, v60, v12
    v_fmac_f32 v45, v61, v12
    v_fmac_f32 v46, v62, v12
    v_fmac_f32 v47, v63, v12
    s_waitcnt vmcnt(1)
    v_lshlrev_b32 v56, 16, v28
    v_and_b32 v57, 0xffff0000, v28
    v_lshlrev_b32 v58, 16, v29
    v_and_b32 v59, 0xffff0000, v29
    v_lshlrev_b32 v60, 16, v30
    v_and_b32 v61, 0xffff0000, v30
    v_lshlrev_b32 v62, 16, v31
    v_and_b32 v63, 0xffff0000, v31
    v_fmac_f32 v40, v56, v13
    v_fmac_f32 v41, v57, v13
    v_fmac_f32 v42, v58, v13
    v_fmac_f32 v43, v59, v13
    v_fmac_f32 v44, v60, v13
    v_fmac_f32 v45, v61, v13
    v_fmac_f32 v46, v62, v13
    v_fmac_f32 v47, v63, v13
    s_waitcnt vmcnt(0)
    v_lshlrev_b32 v56, 16, v32
    v_and_b32 v57, 0xffff0000, v32
    v_lshlrev_b32 v58, 16, v33
    v_and_b32 v59, 0xffff0000, v33
    v_lshlrev_b32 v60, 16, v34
    v_and_b32 v61, 0xffff0000, v34
    v_lshlrev_b32 v62, 16, v35
    v_and_b32 v63, 0xffff0000, v35
    v_fmac_f32 v40, v56, v14
    v_fmac_f32 v41, v57, v14
    v_fmac_f32 v42, v58, v14
    v_fmac_f32 v43, v59, v14
    v_fmac_f32 v44, v60, v14
    v_fmac_f32 v45, v61, v14
    v_fmac_f32 v46, v62, v14
    v_fmac_f32 v47, v63, v14
    ds_write_b128 v5, v[40:43]
    ds_write_b128 v5, v[44:47] offset:16
    s_mul_i32 s26, s24, 15360
    s_lshl_b32 s27, s25, 8
    s_add_u32 s26, s26, s27
    v_readfirstlane_b32 s28, v0
    s_waitcnt lgkmcnt(0)
    s_barrier
    s_cmp_ge_u32 s28, 64
    s_nop 1
    s_cbranch_scc1 L1_end
    v_lshlrev_b32 v5, 2, v0
    ds_read_b32 v10, v5 offset:0
    ds_read_b32 v11, v5 offset:256
    ds_read_b32 v12, v5 offset:512
    ds_read_b32 v13, v5 offset:768
    ds_read_b32 v14, v5 offset:1024
    ds_read_b32 v15, v5 offset:1280
    ds_read_b32 v16, v5 offset:1536
    ds_read_b32 v17, v5 offset:1792
    ds_read_b32 v18, v5 offset:2048
    ds_read_b32 v19, v5 offset:2304
    ds_read_b32 v20, v5 offset:2560
    ds_read_b32 v21, v5 offset:2816
    ds_read_b32 v22, v5 offset:3072
    ds_read_b32 v23, v5 offset:3328
    ds_read_b32 v24, v5 offset:3584
    ds_read_b32 v25, v5 offset:3840
    ds_read_b32 v26, v5 offset:4096
    ds_read_b32 v27, v5 offset:4352
    ds_read_b32 v28, v5 offset:4608
    ds_read_b32 v29, v5 offset:4864
    ds_read_b32 v30, v5 offset:5120
    ds_read_b32 v31, v5 offset:5376
    ds_read_b32 v32, v5 offset:5632
    ds_read_b32 v33, v5 offset:5888
    ds_read_b32 v34, v5 offset:6144
    ds_read_b32 v35, v5 offset:6400
    ds_read_b32 v36, v5 offset:6656
    ds_read_b32 v37, v5 offset:6912
    ds_read_b32 v38, v5 offset:7168
    ds_read_b32 v39, v5 offset:7424
    ds_read_b32 v40, v5 offset:7680
    ds_read_b32 v41, v5 offset:7936
    s_waitcnt lgkmcnt(0)
    v_add_f32 v10, v10, v26
    v_add_f32 v11, v11, v27
    v_add_f32 v12, v12, v28
    v_add_f32 v13, v13, v29
    v_add_f32 v14, v14, v30
    v_add_f32 v15, v15, v31
    v_add_f32 v16, v16, v32
    v_add_f32 v17, v17, v33
    v_add_f32 v18, v18, v34
    v_add_f32 v19, v19, v35
    v_add_f32 v20, v20, v36
    v_add_f32 v21, v21, v37
    v_add_f32 v22, v22, v38
    v_add_f32 v23, v23, v39
    v_add_f32 v24, v24, v40
    v_add_f32 v25, v25, v41
    v_add_f32 v10, v10, v18
    v_add_f32 v11, v11, v19
    v_add_f32 v12, v12, v20
    v_add_f32 v13, v13, v21
    v_add_f32 v14, v14, v22
    v_add_f32 v15, v15, v23
    v_add_f32 v16, v16, v24
    v_add_f32 v17, v17, v25
    v_add_f32 v10, v10, v14
    v_add_f32 v11, v11, v15
    v_add_f32 v12, v12, v16
    v_add_f32 v13, v13, v17
    v_add_f32 v10, v10, v12
    v_add_f32 v11, v11, v13
    v_add_f32 v10, v10, v11
    buffer_store_dword v10, v5, s[12:15], s26 offen offset:0
    s_endpgm
L1_zero:
    v_lshlrev_b32 v1, 4, v0
    v_mov_b32 v4, 0
    v_mov_b32 v5, 0
    v_mov_b32 v6, 0
    v_mov_b32 v7, 0
    s_waitcnt lgkmcnt(0)
    s_mov_b32 s20, 393216
    buffer_store_dwordx4 v[4:7], v1, s[12:15], s20 offen
    s_mov_b32 s20, 397312
    buffer_store_dwordx4 v[4:7], v1, s[12:15], s20 offen
    s_mov_b32 s20, 401408
    buffer_store_dwordx4 v[4:7], v1, s[12:15], s20 offen
    s_mov_b32 s20, 405504
    buffer_store_dwordx4 v[4:7], v1, s[12:15], s20 offen
    s_endpgm
    s_nop 0
L1_notmod:
    s_cmp_ge_u32 s2, 172
    s_cbranch_scc0 L1_fold
    s_load_dwordx2 s[4:5], s[0:1], 0
    s_load_dwordx2 s[8:9], s[0:1], 96
    s_mov_b32 s6, 2621440
    s_mov_b32 s7, 0x20000
    s_mov_b32 s10, 268435456
    s_mov_b32 s11, 0x20000
    v_and_b32 v1, 15, v0
    v_lshrrev_b32 v2, 4, v0
    v_mul_u32_u24 v3, 1280, v2
    v_lshl_add_u32 v3, v1, 4, v3
    s_sub_u32 s12, s2, 172
    s_mul_i32 s12, s12, 40960
    s_add_u32 s13, s12, 20480
    s_waitcnt lgkmcnt(0)
    buffer_load_dwordx4 v[20:23], v3, s[4:7], s12 offen offset:0
    buffer_load_dwordx4 v[24:27], v3, s[4:7], s12 offen offset:256
    buffer_load_dwordx4 v[28:31], v3, s[4:7], s12 offen offset:512
    buffer_load_dwordx4 v[32:35], v3, s[4:7], s12 offen offset:768
    buffer_load_dwordx4 v[36:39], v3, s[4:7], s12 offen offset:1024
    buffer_load_dwordx4 v[40:43], v3, s[4:7], s13 offen offset:0
    buffer_load_dwordx4 v[44:47], v3, s[4:7], s13 offen offset:256
    buffer_load_dwordx4 v[48:51], v3, s[4:7], s13 offen offset:512
    buffer_load_dwordx4 v[52:55], v3, s[4:7], s13 offen offset:768
    buffer_load_dwordx4 v[56:59], v3, s[4:7], s13 offen offset:1024
    v_lshrrev_b32 v10, 2, v1
    v_lshlrev_b32 v10, 10, v10
    v_and_b32 v11, 3, v1
    v_lshl_add_u32 v10, v11, 8, v10
    v_lshl_add_u32 v10, v2, 4, v10
    s_add_u32 s12, s12, 2621440
    s_waitcnt vmcnt(5)
    v_lshlrev_b32 v80, 16, v20
    v_and_b32 v81, 0xffff0000, v20
    v_lshlrev_b32 v82, 16, v21
    v_and_b32 v83, 0xffff0000, v21
    v_lshlrev_b32 v84, 16, v22
    v_and_b32 v85, 0xffff0000, v22
    v_lshlrev_b32 v86, 16, v23
    v_and_b32 v87, 0xffff0000, v23
    v_add_f32 v4, v80, v84
    v_add_f32 v5, v81, v85
    v_add_f32 v6, v82, v86
    v_add_f32 v7, v83, v87
    v_lshlrev_b32 v88, 16, v24
    v_and_b32 v89, 0xffff0000, v24
    v_lshlrev_b32 v90, 16, v25
    v_and_b32 v91, 0xffff0000, v25
    v_lshlrev_b32 v92, 16, v26
    v_and_b32 v93, 0xffff0000, v26
    v_lshlrev_b32 v94, 16, v27
    v_and_b32 v95, 0xffff0000, v27
    v_add_f32 v4, v4, v88
    v_add_f32 v5, v5, v89
    v_add_f32 v6, v6, v90
    v_add_f32 v7, v7, v91
    v_add_f32 v4, v4, v92
    v_add_f32 v5, v5, v93
    v_add_f32 v6, v6, v94
    v_add_f32 v7, v7, v95
    v_lshlrev_b32 v96, 16, v28
    v_and_b32 v97, 0xffff0000, v28
    v_lshlrev_b32 v98, 16, v29
    v_and_b32 v99, 0xffff0000, v29
    v_lshlrev_b32 v100, 16, v30
    v_and_b32 v101, 0xffff0000, v30
    v_lshlrev_b32 v102, 16, v31
    v_and_b32 v103, 0xffff0000, v31
    v_add_f32 v4, v4, v96
    v_add_f32 v5, v5, v97
    v_add_f32 v6, v6, v98
    v_add_f32 v7, v7, v99
    v_add_f32 v4, v4, v100
    v_add_f32 v5, v5, v101
    v_add_f32 v6, v6, v102
    v_add_f32 v7, v7, v103
    v_lshlrev_b32 v104, 16, v32
    v_and_b32 v105, 0xffff0000, v32
    v_lshlrev_b32 v106, 16, v33
    v_and_b32 v107, 0xffff0000, v33
    v_lshlrev_b32 v108, 16, v34
    v_and_b32 v109, 0xffff0000, v34
    v_lshlrev_b32 v110, 16, v35
    v_and_b32 v111, 0xffff0000, v35
    v_add_f32 v4, v4, v104
    v_add_f32 v5, v5, v105
    v_add_f32 v6, v6, v106
    v_add_f32 v7, v7, v107
    v_add_f32 v4, v4, v108
    v_add_f32 v5, v5, v109
    v_add_f32 v6, v6, v110
    v_add_f32 v7, v7, v111
    v_lshlrev_b32 v112, 16, v36
    v_and_b32 v113, 0xffff0000, v36
    v_lshlrev_b32 v114, 16, v37
    v_and_b32 v115, 0xffff0000, v37
    v_lshlrev_b32 v116, 16, v38
    v_and_b32 v117, 0xffff0000, v38
    v_lshlrev_b32 v118, 16, v39
    v_and_b32 v119, 0xffff0000, v39
    v_add_f32 v4, v4, v112
    v_add_f32 v5, v5, v113
    v_add_f32 v6, v6, v114
    v_add_f32 v7, v7, v115
    v_add_f32 v4, v4, v116
    v_add_f32 v5, v5, v117
    v_add_f32 v6, v6, v118
    v_add_f32 v7, v7, v119
    v_add_f32 v4, v4, v5
    v_add_f32 v6, v6, v7
    v_add_f32 v4, v4, v6
    s_nop 1
    v_add_f32_dpp v4, v4, v4 row_ror:8 row_mask:0xf bank_mask:0xf
    s_nop 1
    v_add_f32_dpp v4, v4, v4 row_ror:4 row_mask:0xf bank_mask:0xf
    s_nop 1
    v_add_f32_dpp v4, v4, v4 row_ror:2 row_mask:0xf bank_mask:0xf
    s_nop 1
    v_add_f32_dpp v4, v4, v4 row_ror:1 row_mask:0xf bank_mask:0xf
    v_mul_f32 v4, 0x3acccccd, v4
    v_sub_f32 v80, v80, v4
    v_sub_f32 v81, v81, v4
    v_sub_f32 v82, v82, v4
    v_sub_f32 v83, v83, v4
    v_sub_f32 v84, v84, v4
    v_sub_f32 v85, v85, v4
    v_sub_f32 v86, v86, v4
    v_sub_f32 v87, v87, v4
    v_sub_f32 v88, v88, v4
    v_sub_f32 v89, v89, v4
    v_sub_f32 v90, v90, v4
    v_sub_f32 v91, v91, v4
    v_sub_f32 v92, v92, v4
    v_sub_f32 v93, v93, v4
    v_sub_f32 v94, v94, v4
    v_sub_f32 v95, v95, v4
    v_sub_f32 v96, v96, v4
    v_sub_f32 v97, v97, v4
    v_sub_f32 v98, v98, v4
    v_sub_f32 v99, v99, v4
    v_sub_f32 v100, v100, v4
    v_sub_f32 v101, v101, v4
    v_sub_f32 v102, v102, v4
    v_sub_f32 v103, v103, v4
    v_sub_f32 v104, v104, v4
    v_sub_f32 v105, v105, v4
    v_sub_f32 v106, v106, v4
    v_sub_f32 v107, v107, v4
    v_sub_f32 v108, v108, v4
    v_sub_f32 v109, v109, v4
    v_sub_f32 v110, v110, v4
    v_sub_f32 v111, v111, v4
    v_sub_f32 v112, v112, v4
    v_sub_f32 v113, v113, v4
    v_sub_f32 v114, v114, v4
    v_sub_f32 v115, v115, v4
    v_sub_f32 v116, v116, v4
    v_sub_f32 v117, v117, v4
    v_sub_f32 v118, v118, v4
    v_sub_f32 v119, v119, v4
    v_mul_f32 v12, v80, v80
    v_mul_f32 v13, v81, v81
    v_mul_f32 v14, v82, v82
    v_mul_f32 v15, v83, v83
    v_fmac_f32 v12, v84, v84
    v_fmac_f32 v13, v85, v85
    v_fmac_f32 v14, v86, v86
    v_fmac_f32 v15, v87, v87
    v_fmac_f32 v12, v88, v88
    v_fmac_f32 v13, v89, v89
    v_fmac_f32 v14, v90, v90
    v_fmac_f32 v15, v91, v91
    v_fmac_f32 v12, v92, v92
    v_fmac_f32 v13, v93, v93
    v_fmac_f32 v14, v94, v94
    v_fmac_f32 v15, v95, v95
    v_fmac_f32 v12, v96, v96
    v_fmac_f32 v13, v97, v97
    v_fmac_f32 v14, v98, v98
    v_fmac_f32 v15, v99, v99
    v_fmac_f32 v12, v100, v100
    v_fmac_f32 v13, v101, v101
    v_fmac_f32 v14, v102, v102
    v_fmac_f32 v15, v103, v103
    v_fmac_f32 v12, v104, v104
    v_fmac_f32 v13, v105, v105
    v_fmac_f32 v14, v106, v106
    v_fmac_f32 v15, v107, v107
    v_fmac_f32 v12, v108, v108
    v_fmac_f32 v13, v109, v109
    v_fmac_f32 v14, v110, v110
    v_fmac_f32 v15, v111, v111
    v_fmac_f32 v12, v112, v112
    v_fmac_f32 v13, v113, v113
    v_fmac_f32 v14, v114, v114
    v_fmac_f32 v15, v115, v115
    v_fmac_f32 v12, v116, v116
    v_fmac_f32 v13, v117, v117
    v_fmac_f32 v14, v118, v118
    v_fmac_f32 v15, v119, v119
    v_add_f32 v12, v12, v13
    v_add_f32 v14, v14, v15
    v_add_f32 v12, v12, v14
    s_nop 1
    v_add_f32_dpp v12, v12, v12 row_ror:8 row_mask:0xf bank_mask:0xf
    s_nop 1
    v_add_f32_dpp v12, v12, v12 row_ror:4 row_mask:0xf bank_mask:0xf
    s_nop 1
    v_add_f32_dpp v12, v12, v12 row_ror:2 row_mask:0xf bank_mask:0xf
    s_nop 1
    v_add_f32_dpp v12, v12, v12 row_ror:1 row_mask:0xf bank_mask:0xf
    v_mov_b32 v8, 0x3727c5ac
    v_fmac_f32 v8, 0x3acccccd, v12
    v_rsq_f32 v8, v8
    s_nop 0
    v_mul_f32 v80, v80, v8
    v_mul_f32 v81, v81, v8
    v_mul_f32 v82, v82, v8
    v_mul_f32 v83, v83, v8
    v_mul_f32 v84, v84, v8
    v_mul_f32 v85, v85, v8
    v_mul_f32 v86, v86, v8
    v_mul_f32 v87, v87, v8
    v_cvt_pk_f16_f32 v20, v80, v81
    v_cvt_pk_f16_f32 v21, v82, v83
    v_cvt_pk_f16_f32 v22, v84, v85
    v_cvt_pk_f16_f32 v23, v86, v87
    buffer_store_dwordx4 v[20:23], v10, s[8:11], s12 offen
    s_add_u32 s12, s12, 4096
    v_mul_f32 v88, v88, v8
    v_mul_f32 v89, v89, v8
    v_mul_f32 v90, v90, v8
    v_mul_f32 v91, v91, v8
    v_mul_f32 v92, v92, v8
    v_mul_f32 v93, v93, v8
    v_mul_f32 v94, v94, v8
    v_mul_f32 v95, v95, v8
    v_cvt_pk_f16_f32 v24, v88, v89
    v_cvt_pk_f16_f32 v25, v90, v91
    v_cvt_pk_f16_f32 v26, v92, v93
    v_cvt_pk_f16_f32 v27, v94, v95
    buffer_store_dwordx4 v[24:27], v10, s[8:11], s12 offen
    s_add_u32 s12, s12, 4096
    v_mul_f32 v96, v96, v8
    v_mul_f32 v97, v97, v8
    v_mul_f32 v98, v98, v8
    v_mul_f32 v99, v99, v8
    v_mul_f32 v100, v100, v8
    v_mul_f32 v101, v101, v8
    v_mul_f32 v102, v102, v8
    v_mul_f32 v103, v103, v8
    v_cvt_pk_f16_f32 v28, v96, v97
    v_cvt_pk_f16_f32 v29, v98, v99
    v_cvt_pk_f16_f32 v30, v100, v101
    v_cvt_pk_f16_f32 v31, v102, v103
    buffer_store_dwordx4 v[28:31], v10, s[8:11], s12 offen
    s_add_u32 s12, s12, 4096
    v_mul_f32 v104, v104, v8
    v_mul_f32 v105, v105, v8
    v_mul_f32 v106, v106, v8
    v_mul_f32 v107, v107, v8
    v_mul_f32 v108, v108, v8
    v_mul_f32 v109, v109, v8
    v_mul_f32 v110, v110, v8
    v_mul_f32 v111, v111, v8
    v_cvt_pk_f16_f32 v32, v104, v105
    v_cvt_pk_f16_f32 v33, v106, v107
    v_cvt_pk_f16_f32 v34, v108, v109
    v_cvt_pk_f16_f32 v35, v110, v111
    buffer_store_dwordx4 v[32:35], v10, s[8:11], s12 offen
    s_add_u32 s12, s12, 4096
    v_mul_f32 v112, v112, v8
    v_mul_f32 v113, v113, v8
    v_mul_f32 v114, v114, v8
    v_mul_f32 v115, v115, v8
    v_mul_f32 v116, v116, v8
    v_mul_f32 v117, v117, v8
    v_mul_f32 v118, v118, v8
    v_mul_f32 v119, v119, v8
    v_cvt_pk_f16_f32 v36, v112, v113
    v_cvt_pk_f16_f32 v37, v114, v115
    v_cvt_pk_f16_f32 v38, v116, v117
    v_cvt_pk_f16_f32 v39, v118, v119
    buffer_store_dwordx4 v[36:39], v10, s[8:11], s12 offen
    s_add_u32 s12, s12, 4096
    s_waitcnt vmcnt(5)
    v_lshlrev_b32 v80, 16, v40
    v_and_b32 v81, 0xffff0000, v40
    v_lshlrev_b32 v82, 16, v41
    v_and_b32 v83, 0xffff0000, v41
    v_lshlrev_b32 v84, 16, v42
    v_and_b32 v85, 0xffff0000, v42
    v_lshlrev_b32 v86, 16, v43
    v_and_b32 v87, 0xffff0000, v43
    v_add_f32 v4, v80, v84
    v_add_f32 v5, v81, v85
    v_add_f32 v6, v82, v86
    v_add_f32 v7, v83, v87
    v_lshlrev_b32 v88, 16, v44
    v_and_b32 v89, 0xffff0000, v44
    v_lshlrev_b32 v90, 16, v45
    v_and_b32 v91, 0xffff0000, v45
    v_lshlrev_b32 v92, 16, v46
    v_and_b32 v93, 0xffff0000, v46
    v_lshlrev_b32 v94, 16, v47
    v_and_b32 v95, 0xffff0000, v47
    v_add_f32 v4, v4, v88
    v_add_f32 v5, v5, v89
    v_add_f32 v6, v6, v90
    v_add_f32 v7, v7, v91
    v_add_f32 v4, v4, v92
    v_add_f32 v5, v5, v93
    v_add_f32 v6, v6, v94
    v_add_f32 v7, v7, v95
    v_lshlrev_b32 v96, 16, v48
    v_and_b32 v97, 0xffff0000, v48
    v_lshlrev_b32 v98, 16, v49
    v_and_b32 v99, 0xffff0000, v49
    v_lshlrev_b32 v100, 16, v50
    v_and_b32 v101, 0xffff0000, v50
    v_lshlrev_b32 v102, 16, v51
    v_and_b32 v103, 0xffff0000, v51
    v_add_f32 v4, v4, v96
    v_add_f32 v5, v5, v97
    v_add_f32 v6, v6, v98
    v_add_f32 v7, v7, v99
    v_add_f32 v4, v4, v100
    v_add_f32 v5, v5, v101
    v_add_f32 v6, v6, v102
    v_add_f32 v7, v7, v103
    v_lshlrev_b32 v104, 16, v52
    v_and_b32 v105, 0xffff0000, v52
    v_lshlrev_b32 v106, 16, v53
    v_and_b32 v107, 0xffff0000, v53
    v_lshlrev_b32 v108, 16, v54
    v_and_b32 v109, 0xffff0000, v54
    v_lshlrev_b32 v110, 16, v55
    v_and_b32 v111, 0xffff0000, v55
    v_add_f32 v4, v4, v104
    v_add_f32 v5, v5, v105
    v_add_f32 v6, v6, v106
    v_add_f32 v7, v7, v107
    v_add_f32 v4, v4, v108
    v_add_f32 v5, v5, v109
    v_add_f32 v6, v6, v110
    v_add_f32 v7, v7, v111
    v_lshlrev_b32 v112, 16, v56
    v_and_b32 v113, 0xffff0000, v56
    v_lshlrev_b32 v114, 16, v57
    v_and_b32 v115, 0xffff0000, v57
    v_lshlrev_b32 v116, 16, v58
    v_and_b32 v117, 0xffff0000, v58
    v_lshlrev_b32 v118, 16, v59
    v_and_b32 v119, 0xffff0000, v59
    v_add_f32 v4, v4, v112
    v_add_f32 v5, v5, v113
    v_add_f32 v6, v6, v114
    v_add_f32 v7, v7, v115
    v_add_f32 v4, v4, v116
    v_add_f32 v5, v5, v117
    v_add_f32 v6, v6, v118
    v_add_f32 v7, v7, v119
    v_add_f32 v4, v4, v5
    v_add_f32 v6, v6, v7
    v_add_f32 v4, v4, v6
    s_nop 1
    v_add_f32_dpp v4, v4, v4 row_ror:8 row_mask:0xf bank_mask:0xf
    s_nop 1
    v_add_f32_dpp v4, v4, v4 row_ror:4 row_mask:0xf bank_mask:0xf
    s_nop 1
    v_add_f32_dpp v4, v4, v4 row_ror:2 row_mask:0xf bank_mask:0xf
    s_nop 1
    v_add_f32_dpp v4, v4, v4 row_ror:1 row_mask:0xf bank_mask:0xf
    v_mul_f32 v4, 0x3acccccd, v4
    v_sub_f32 v80, v80, v4
    v_sub_f32 v81, v81, v4
    v_sub_f32 v82, v82, v4
    v_sub_f32 v83, v83, v4
    v_sub_f32 v84, v84, v4
    v_sub_f32 v85, v85, v4
    v_sub_f32 v86, v86, v4
    v_sub_f32 v87, v87, v4
    v_sub_f32 v88, v88, v4
    v_sub_f32 v89, v89, v4
    v_sub_f32 v90, v90, v4
    v_sub_f32 v91, v91, v4
    v_sub_f32 v92, v92, v4
    v_sub_f32 v93, v93, v4
    v_sub_f32 v94, v94, v4
    v_sub_f32 v95, v95, v4
    v_sub_f32 v96, v96, v4
    v_sub_f32 v97, v97, v4
    v_sub_f32 v98, v98, v4
    v_sub_f32 v99, v99, v4
    v_sub_f32 v100, v100, v4
    v_sub_f32 v101, v101, v4
    v_sub_f32 v102, v102, v4
    v_sub_f32 v103, v103, v4
    v_sub_f32 v104, v104, v4
    v_sub_f32 v105, v105, v4
    v_sub_f32 v106, v106, v4
    v_sub_f32 v107, v107, v4
    v_sub_f32 v108, v108, v4
    v_sub_f32 v109, v109, v4
    v_sub_f32 v110, v110, v4
    v_sub_f32 v111, v111, v4
    v_sub_f32 v112, v112, v4
    v_sub_f32 v113, v113, v4
    v_sub_f32 v114, v114, v4
    v_sub_f32 v115, v115, v4
    v_sub_f32 v116, v116, v4
    v_sub_f32 v117, v117, v4
    v_sub_f32 v118, v118, v4
    v_sub_f32 v119, v119, v4
    v_mul_f32 v12, v80, v80
    v_mul_f32 v13, v81, v81
    v_mul_f32 v14, v82, v82
    v_mul_f32 v15, v83, v83
    v_fmac_f32 v12, v84, v84
    v_fmac_f32 v13, v85, v85
    v_fmac_f32 v14, v86, v86
    v_fmac_f32 v15, v87, v87
    v_fmac_f32 v12, v88, v88
    v_fmac_f32 v13, v89, v89
    v_fmac_f32 v14, v90, v90
    v_fmac_f32 v15, v91, v91
    v_fmac_f32 v12, v92, v92
    v_fmac_f32 v13, v93, v93
    v_fmac_f32 v14, v94, v94
    v_fmac_f32 v15, v95, v95
    v_fmac_f32 v12, v96, v96
    v_fmac_f32 v13, v97, v97
    v_fmac_f32 v14, v98, v98
    v_fmac_f32 v15, v99, v99
    v_fmac_f32 v12, v100, v100
    v_fmac_f32 v13, v101, v101
    v_fmac_f32 v14, v102, v102
    v_fmac_f32 v15, v103, v103
    v_fmac_f32 v12, v104, v104
    v_fmac_f32 v13, v105, v105
    v_fmac_f32 v14, v106, v106
    v_fmac_f32 v15, v107, v107
    v_fmac_f32 v12, v108, v108
    v_fmac_f32 v13, v109, v109
    v_fmac_f32 v14, v110, v110
    v_fmac_f32 v15, v111, v111
    v_fmac_f32 v12, v112, v112
    v_fmac_f32 v13, v113, v113
    v_fmac_f32 v14, v114, v114
    v_fmac_f32 v15, v115, v115
    v_fmac_f32 v12, v116, v116
    v_fmac_f32 v13, v117, v117
    v_fmac_f32 v14, v118, v118
    v_fmac_f32 v15, v119, v119
    v_add_f32 v12, v12, v13
    v_add_f32 v14, v14, v15
    v_add_f32 v12, v12, v14
    s_nop 1
    v_add_f32_dpp v12, v12, v12 row_ror:8 row_mask:0xf bank_mask:0xf
    s_nop 1
    v_add_f32_dpp v12, v12, v12 row_ror:4 row_mask:0xf bank_mask:0xf
    s_nop 1
    v_add_f32_dpp v12, v12, v12 row_ror:2 row_mask:0xf bank_mask:0xf
    s_nop 1
    v_add_f32_dpp v12, v12, v12 row_ror:1 row_mask:0xf bank_mask:0xf
    v_mov_b32 v8, 0x3727c5ac
    v_fmac_f32 v8, 0x3acccccd, v12
    v_rsq_f32 v8, v8
    s_nop 0
    v_mul_f32 v80, v80, v8
    v_mul_f32 v81, v81, v8
    v_mul_f32 v82, v82, v8
    v_mul_f32 v83, v83, v8
    v_mul_f32 v84, v84, v8
    v_mul_f32 v85, v85, v8
    v_mul_f32 v86, v86, v8
    v_mul_f32 v87, v87, v8
    v_cvt_pk_f16_f32 v40, v80, v81
    v_cvt_pk_f16_f32 v41, v82, v83
    v_cvt_pk_f16_f32 v42, v84, v85
    v_cvt_pk_f16_f32 v43, v86, v87
    buffer_store_dwordx4 v[40:43], v10, s[8:11], s12 offen
    s_add_u32 s12, s12, 4096
    v_mul_f32 v88, v88, v8
    v_mul_f32 v89, v89, v8
    v_mul_f32 v90, v90, v8
    v_mul_f32 v91, v91, v8
    v_mul_f32 v92, v92, v8
    v_mul_f32 v93, v93, v8
    v_mul_f32 v94, v94, v8
    v_mul_f32 v95, v95, v8
    v_cvt_pk_f16_f32 v44, v88, v89
    v_cvt_pk_f16_f32 v45, v90, v91
    v_cvt_pk_f16_f32 v46, v92, v93
    v_cvt_pk_f16_f32 v47, v94, v95
    buffer_store_dwordx4 v[44:47], v10, s[8:11], s12 offen
    s_add_u32 s12, s12, 4096
    v_mul_f32 v96, v96, v8
    v_mul_f32 v97, v97, v8
    v_mul_f32 v98, v98, v8
    v_mul_f32 v99, v99, v8
    v_mul_f32 v100, v100, v8
    v_mul_f32 v101, v101, v8
    v_mul_f32 v102, v102, v8
    v_mul_f32 v103, v103, v8
    v_cvt_pk_f16_f32 v48, v96, v97
    v_cvt_pk_f16_f32 v49, v98, v99
    v_cvt_pk_f16_f32 v50, v100, v101
    v_cvt_pk_f16_f32 v51, v102, v103
    buffer_store_dwordx4 v[48:51], v10, s[8:11], s12 offen
    s_add_u32 s12, s12, 4096
    v_mul_f32 v104, v104, v8
    v_mul_f32 v105, v105, v8
    v_mul_f32 v106, v106, v8
    v_mul_f32 v107, v107, v8
    v_mul_f32 v108, v108, v8
    v_mul_f32 v109, v109, v8
    v_mul_f32 v110, v110, v8
    v_mul_f32 v111, v111, v8
    v_cvt_pk_f16_f32 v52, v104, v105
    v_cvt_pk_f16_f32 v53, v106, v107
    v_cvt_pk_f16_f32 v54, v108, v109
    v_cvt_pk_f16_f32 v55, v110, v111
    buffer_store_dwordx4 v[52:55], v10, s[8:11], s12 offen
    s_add_u32 s12, s12, 4096
    v_mul_f32 v112, v112, v8
    v_mul_f32 v113, v113, v8
    v_mul_f32 v114, v114, v8
    v_mul_f32 v115, v115, v8
    v_mul_f32 v116, v116, v8
    v_mul_f32 v117, v117, v8
    v_mul_f32 v118, v118, v8
    v_mul_f32 v119, v119, v8
    v_cvt_pk_f16_f32 v56, v112, v113
    v_cvt_pk_f16_f32 v57, v114, v115
    v_cvt_pk_f16_f32 v58, v116, v117
    v_cvt_pk_f16_f32 v59, v118, v119
    buffer_store_dwordx4 v[56:59], v10, s[8:11], s12 offen
    s_add_u32 s12, s12, 4096
    s_endpgm
L1_fold:
    s_load_dwordx2 s[4:5], s[0:1], 96
    s_load_dwordx2 s[20:21], s[0:1], 8
    s_load_dwordx2 s[24:25], s[0:1], 16
    s_load_dwordx2 s[12:13], s[0:1], 24
    s_load_dwordx2 s[16:17], s[0:1], 56
    s_mov_b32 s6, 268435456
    s_mov_b32 s7, 0x20000
    s_mov_b32 s22, 2457600
    s_mov_b32 s23, 0x20000
    s_mov_b32 s26, 25600
    s_mov_b32 s27, 0x20000
    s_mov_b32 s14, 819200
    s_mov_b32 s15, 0x20000
    s_mov_b32 s18, 2211840
    s_mov_b32 s19, 0x20000
    v_lshrrev_b32 v1, 6, v0
    s_nop 0
    v_readfirstlane_b32 s8, v1
    v_and_b32 v0, 63, v0
    v_and_b32 v1, 15, v0
    v_lshrrev_b32 v2, 4, v0
    v_lshrrev_b32 v3, 2, v1
    v_and_b32 v4, 3, v1
    v_lshl_add_u32 v5, v3, 3, v4
    v_lshlrev_b32 v10, 4, v0
    s_cmp_lt_u32 s2, 120
    s_nop 0
    s_cbranch_scc1 L1_fold2
    s_lshl_b32 s28, s8, 2
    v_add_u32 v6, s28, v2
    v_xor_b32 v6, v6, v1
    v_lshlrev_b32 v6, 4, v6
    s_lshl_b32 s35, s8, 10
    s_waitcnt lgkmcnt(0)
    s_cmp_ge_u32 s2, 132
    s_cselect_b32 s40, s12, s16
    s_cselect_b32 s41, s13, s17
    s_cselect_b32 s42, 819200, s18
    s_mov_b32 s43, 0x20000
    s_cselect_b32 s28, 12, -96
    s_cselect_b32 s36, 10, 27
    s_cselect_b32 s37, 0, 170
    s_cselect_b32 s38, 0, 15728640
    s_add_u32 s37, s37, 100
    s_sub_u32 s28, s2, s28
    s_sub_u32 s28, s28, 120
    s_and_b32 s29, s28, 1
    s_lshr_b32 s28, s28, 1
    v_mul_u32_u24 v7, 1280, v2
    v_add_u32 v6, v6, v7
    s_mul_i32 s30, s28, 40960
    s_mul_i32 s31, s29, 640
    s_add_u32 s30, s30, s31
    s_mul_i32 s31, s8, 5120
    s_add_u32 s30, s30, s31
    s_add_u32 s31, s30, 20480
    s_add_u32 m0, s35, 0
    s_nop 0
    buffer_load_dwordx4 v6, s[40:43], s30 offen offset:0 lds
    s_add_u32 m0, s35, 4096
    s_nop 0
    buffer_load_dwordx4 v6, s[40:43], s31 offen offset:0 lds
    s_add_u32 m0, s35, 7936
    s_nop 0
    buffer_load_dwordx4 v6, s[40:43], s30 offen offset:256 lds
    s_add_u32 m0, s35, 12032
    s_nop 0
    buffer_load_dwordx4 v6, s[40:43], s31 offen offset:256 lds
    s_add_u32 m0, s35, 15872
    s_nop 0
    buffer_load_dwordx4 v6, s[40:43], s30 offen offset:512 lds
    s_add_u32 m0, s35, 19968
    s_nop 0
    buffer_load_dwordx4 v6, s[40:43], s31 offen offset:512 lds
    v_lshlrev_b32 v12, 3, v2
    v_sub_u32 v12, v5, v12
    v_mov_b32 v13, 0x3f80
    v_mov_b32 v14, 0x3f800000
    v_cmp_eq_u32 vcc, 0, v12
    v_cmp_eq_u32 s[56:57], 1, v12
    s_nop 0
    v_cndmask_b32 v16, 0, v13, vcc
    v_cndmask_b32 v16, v16, v14, s[56:57]
    v_cmp_eq_u32 vcc, 2, v12
    v_cmp_eq_u32 s[56:57], 3, v12
    s_nop 0
    v_cndmask_b32 v17, 0, v13, vcc
    v_cndmask_b32 v17, v17, v14, s[56:57]
    v_cmp_eq_u32 vcc, 4, v12
    v_cmp_eq_u32 s[56:57], 5, v12
    s_nop 0
    v_cndmask_b32 v18, 0, v13, vcc
    v_cndmask_b32 v18, v18, v14, s[56:57]
    v_cmp_eq_u32 vcc, 6, v12
    v_cmp_eq_u32 s[56:57], 7, v12
    s_nop 0
    v_cndmask_b32 v19, 0, v13, vcc
    v_cndmask_b32 v19, v19, v14, s[56:57]
    v_cmp_eq_u32 vcc, -4, v12
    v_cmp_eq_u32 s[56:57], -3, v12
    s_nop 0
    v_cndmask_b32 v20, 0, v13, vcc
    v_cndmask_b32 v20, v20, v14, s[56:57]
    v_cmp_eq_u32 vcc, -2, v12
    v_cmp_eq_u32 s[56:57], -1, v12
    s_nop 0
    v_cndmask_b32 v21, 0, v13, vcc
    v_cndmask_b32 v21, v21, v14, s[56:57]
    v_cmp_eq_u32 vcc, 0, v12
    v_cmp_eq_u32 s[56:57], 1, v12
    s_nop 0
    v_cndmask_b32 v22, 0, v13, vcc
    v_cndmask_b32 v22, v22, v14, s[56:57]
    v_cmp_eq_u32 vcc, 2, v12
    v_cmp_eq_u32 s[56:57], 3, v12
    s_nop 0
    v_cndmask_b32 v23, 0, v13, vcc
    v_cndmask_b32 v23, v23, v14, s[56:57]
    v_lshlrev_b32 v12, 3, v2
    v_sub_u32 v12, v1, v12
    v_mov_b32 v13, 0x3f80
    v_mov_b32 v14, 0x3f800000
    v_cmp_eq_u32 vcc, 0, v12
    v_cmp_eq_u32 s[56:57], 1, v12
    s_nop 0
    v_cndmask_b32 v24, 0, v13, vcc
    v_cndmask_b32 v24, v24, v14, s[56:57]
    v_cmp_eq_u32 vcc, 2, v12
    v_cmp_eq_u32 s[56:57], 3, v12
    s_nop 0
    v_cndmask_b32 v25, 0, v13, vcc
    v_cndmask_b32 v25, v25, v14, s[56:57]
    v_cmp_eq_u32 vcc, 4, v12
    v_cmp_eq_u32 s[56:57], 5, v12
    s_nop 0
    v_cndmask_b32 v26, 0, v13, vcc
    v_cndmask_b32 v26, v26, v14, s[56:57]
    v_cmp_eq_u32 vcc, 6, v12
    v_cmp_eq_u32 s[56:57], 7, v12
    s_nop 0
    v_cndmask_b32 v27, 0, v13, vcc
    v_cndmask_b32 v27, v27, v14, s[56:57]
    s_mul_i32 s32, s8, 10
    v_add_u32 v120, s32, v2
    v_add_u32 v8, 0, v5
    v_xor_b32 v9, v8, v120
    v_and_b32 v9, 15, v9
    v_lshrrev_b32 v120, 4, v120
    v_lshlrev_b32 v120, 13, v120
    v_lshl_add_u32 v120, v8, 8, v120
    v_lshl_add_u32 v120, v9, 4, v120
    v_add_u32 v121, s32, v2
    v_add_u32 v8, 4, v5
    v_xor_b32 v9, v8, v121
    v_and_b32 v9, 15, v9
    v_lshrrev_b32 v121, 4, v121
    v_lshlrev_b32 v121, 13, v121
    v_lshl_add_u32 v121, v8, 8, v121
    v_lshl_add_u32 v121, v9, 4, v121
    v_add_u32 v122, s32, v2
    v_add_u32 v122, 4, v122
    v_add_u32 v8, 0, v5
    v_xor_b32 v9, v8, v122
    v_and_b32 v9, 15, v9
    v_lshrrev_b32 v122, 4, v122
    v_lshlrev_b32 v122, 13, v122
    v_lshl_add_u32 v122, v8, 8, v122
    v_lshl_add_u32 v122, v9, 4, v122
    v_add_u32 v123, s32, v2
    v_add_u32 v123, 4, v123
    v_add_u32 v8, 4, v5
    v_xor_b32 v9, v8, v123
    v_and_b32 v9, 15, v9
    v_lshrrev_b32 v123, 4, v123
    v_lshlrev_b32 v123, 13, v123
    v_lshl_add_u32 v123, v8, 8, v123
    v_lshl_add_u32 v123, v9, 4, v123
    v_and_b32 v124, 1, v2
    v_add_u32 v124, s32, v124
    v_add_u32 v124, 8, v124
    v_add_u32 v8, 0, v5
    v_xor_b32 v9, v8, v124
    v_and_b32 v9, 15, v9
    v_lshrrev_b32 v124, 4, v124
    v_lshlrev_b32 v124, 13, v124
    v_lshl_add_u32 v124, v8, 8, v124
    v_lshl_add_u32 v124, v9, 4, v124
    v_and_b32 v125, 1, v2
    v_add_u32 v125, s32, v125
    v_add_u32 v125, 8, v125
    v_add_u32 v8, 4, v5
    v_xor_b32 v9, v8, v125
    v_and_b32 v9, 15, v9
    v_lshrrev_b32 v125, 4, v125
    v_lshlrev_b32 v125, 13, v125
    v_lshl_add_u32 v125, v8, 8, v125
    v_lshl_add_u32 v125, v9, 4, v125
    s_cmp_ge_u32 s28, s36
    s_cselect_b32 s18, 1, 0
    s_mul_i32 s19, s18, s36
    s_sub_u32 s17, s28, s19
    s_lshl_b32 s17, s17, 1
    s_add_u32 s17, s17, s18
    s_mul_i32 s17, s17, 5
    s_lshl_b32 s33, s29, 2
    s_add_u32 s33, s33, s8
    s_mul_i32 s18, s33, s37
    s_add_u32 s17, s17, s18
    s_lshl_b32 s17, s17, 10
    s_add_u32 s17, s17, s38
    s_add_u32 s17, s17, 16252928
    s_waitcnt vmcnt(0)
    s_barrier
    ds_read_b128 v[40:43], v120
    ds_read_b128 v[52:55], v121
    ds_read_b128 v[44:47], v122
    ds_read_b128 v[56:59], v123
    ds_read_b128 v[48:51], v124
    ds_read_b128 v[60:63], v125
    s_waitcnt lgkmcnt(0)
    v_mfma_f32_16x16x32_bf16 v[96:99], v[40:43], v[16:19], 0
    v_mfma_f32_16x16x32_bf16 v[100:103], v[52:55], v[16:19], 0
    s_nop 6
    v_cvt_pk_bf16_f32 v112, v96, v97
    v_cvt_pk_bf16_f32 v113, v98, v99
    v_cvt_pk_bf16_f32 v114, v100, v101
    v_cvt_pk_bf16_f32 v115, v102, v103
    buffer_store_dwordx4 v[112:115], v10, s[4:7], s17 offen offset:0
    v_mfma_f32_16x16x32_bf16 v[104:107], v[40:43], v[20:23], 0
    v_mfma_f32_16x16x32_bf16 v[108:111], v[52:55], v[20:23], 0
    s_nop 6
    v_cvt_pk_bf16_f32 v116, v104, v105
    v_cvt_pk_bf16_f32 v117, v106, v107
    v_cvt_pk_bf16_f32 v118, v108, v109
    v_cvt_pk_bf16_f32 v119, v110, v111
    buffer_store_dwordx4 v[116:119], v10, s[4:7], s17 offen offset:1024
    v_mfma_f32_16x16x32_bf16 v[96:99], v[44:47], v[16:19], 0
    v_mfma_f32_16x16x32_bf16 v[100:103], v[56:59], v[16:19], 0
    s_nop 6
    v_cvt_pk_bf16_f32 v112, v96, v97
    v_cvt_pk_bf16_f32 v113, v98, v99
    v_cvt_pk_bf16_f32 v114, v100, v101
    v_cvt_pk_bf16_f32 v115, v102, v103
    buffer_store_dwordx4 v[112:115], v10, s[4:7], s17 offen offset:2048
    v_mfma_f32_16x16x32_bf16 v[104:107], v[44:47], v[20:23], 0
    v_mfma_f32_16x16x32_bf16 v[108:111], v[56:59], v[20:23], 0
    s_nop 6
    v_cvt_pk_bf16_f32 v116, v104, v105
    v_cvt_pk_bf16_f32 v117, v106, v107
    v_cvt_pk_bf16_f32 v118, v108, v109
    v_cvt_pk_bf16_f32 v119, v110, v111
    buffer_store_dwordx4 v[116:119], v10, s[4:7], s17 offen offset:3072
    v_mfma_f32_16x16x32_bf16 v[96:99], v[48:51], v[24:27], 0
    v_mfma_f32_16x16x32_bf16 v[100:103], v[60:63], v[24:27], 0
    s_nop 6
    v_cvt_pk_bf16_f32 v112, v96, v97
    v_cvt_pk_bf16_f32 v113, v98, v99
    v_cvt_pk_bf16_f32 v114, v100, v101
    v_cvt_pk_bf16_f32 v115, v102, v103
    s_add_u32 s17, s17, 4096
    buffer_store_dwordx4 v[112:115], v10, s[4:7], s17 offen offset:0
    s_endpgm
    s_nop 0
L1_fold2:
    s_mul_i32 s28, s2, 43
    s_lshr_b32 s28, s28, 8
    s_mul_i32 s29, s28, 6
    s_sub_u32 s29, s2, s29
    s_lshr_b32 s30, s29, 1
    s_and_b32 s29, s29, 1
    s_lshl_b32 s31, s29, 4
    s_lshl_b32 s32, s8, 2
    s_add_u32 s31, s31, s32
    v_mov_b32 v11, 1073741824
    v_mul_u32_u24 v6, 3840, v5
    v_lshl_add_u32 v6, v2, 4, v6
    v_cmp_gt_u32 vcc, 3, v2
    s_nop 1
    v_cndmask_b32 v6, v11, v6, vcc
    s_mul_i32 s32, s28, 122880
    s_mul_i32 s33, s30, 1280
    s_add_u32 s32, s32, s33
    s_mul_i32 s33, s31, 40
    s_add_u32 s32, s32, s33
    s_add_u32 s33, s32, 15360
    s_mul_i32 s34, s31, 800
    s_lshl_b32 s35, s8, 12
    s_waitcnt lgkmcnt(0)
    s_mov_b32 m0, s35
    s_nop 0
    buffer_load_dwordx4 v10, s[24:27], s34 offen offset:0 lds
    buffer_load_dwordx4 v10, s[24:27], s34 offen offset:1024 lds
    buffer_load_dwordx4 v10, s[24:27], s34 offen offset:2048 lds
    buffer_load_dwordx4 v10, s[24:27], s34 offen offset:3072 lds
    buffer_load_dwordx4 v[40:43], v6, s[20:23], s32 offen offset:0
    buffer_load_dwordx4 v[44:47], v6, s[20:23], s33 offen offset:0
    buffer_load_dwordx4 v[48:51], v6, s[20:23], s32 offen offset:40
    buffer_load_dwordx4 v[52:55], v6, s[20:23], s33 offen offset:40
    buffer_load_dwordx4 v[56:59], v6, s[20:23], s32 offen offset:80
    buffer_load_dwordx4 v[60:63], v6, s[20:23], s33 offen offset:80
    buffer_load_dwordx4 v[64:67], v6, s[20:23], s32 offen offset:120
    buffer_load_dwordx4 v[68:71], v6, s[20:23], s33 offen offset:120
    s_cmp_ge_u32 s28, 10
    s_cselect_b32 s36, 1, 0
    s_mul_i32 s37, s36, 10
    s_sub_u32 s37, s28, s37
    s_lshl_b32 s37, s37, 1
    s_add_u32 s37, s37, s36
    s_lshl_b32 s37, s37, 13
    s_lshr_b32 s36, s31, 1
    s_mul_i32 s36, s36, 163840
    s_add_u32 s37, s37, s36
    s_add_u32 s37, s37, 5242880
    s_add_u32 s38, s37, 163840
    v_cmp_eq_u32 s[46:47], 2, v2
    s_cmp_eq_u32 s30, 2
    s_nop 3
    s_cbranch_scc1 L1_v
    s_lshl_b32 s39, s30, 6
    v_lshlrev_b32 v20, 10, v3
    v_lshl_add_u32 v20, v2, 8, v20
    v_lshl_add_u32 v20, v4, 4, v20
    v_add_u32 v20, s39, v20
    v_add_u32 v21, 4096, v20
    v_cmp_gt_u32 vcc, 4, v1
    s_nop 1
    v_cndmask_b32 v21, v11, v21, vcc
    v_add_u32 v22, 128, v20
    v_add_u32 v23, 128, v21
    v_lshl_add_u32 v7, v2, 3, v3
    v_mul_u32_u24 v7, 40, v7
    v_lshl_add_u32 v7, v4, 3, v7
    v_add_u32 v7, s35, v7
    s_waitcnt vmcnt(8)
    ds_read_b64_tr_b16 v[72:73], v7 offset:0
    ds_read_b64_tr_b16 v[74:75], v7 offset:160
    ds_read_b64_tr_b16 v[76:77], v7 offset:32
    ds_read_b64_tr_b16 v[78:79], v7 offset:192
    ds_read_b64_tr_b16 v[80:81], v7 offset:800
    ds_read_b64_tr_b16 v[82:83], v7 offset:960
    ds_read_b64_tr_b16 v[84:85], v7 offset:832
    ds_read_b64_tr_b16 v[86:87], v7 offset:992
    ds_read_b64_tr_b16 v[88:89], v7 offset:1600
    ds_read_b64_tr_b16 v[90:91], v7 offset:1760
    ds_read_b64_tr_b16 v[92:93], v7 offset:1632
    ds_read_b64_tr_b16 v[94:95], v7 offset:1792
    ds_read_b64_tr_b16 v[96:97], v7 offset:2400
    ds_read_b64_tr_b16 v[98:99], v7 offset:2560
    ds_read_b64_tr_b16 v[100:101], v7 offset:2432
    ds_read_b64_tr_b16 v[102:103], v7 offset:2592
    s_branch L1_mm
L1_v:
    v_add_u32 v7, 16, v1
    v_cmp_gt_u32 vcc, 4, v1
    v_mov_b32 v8, 100
    s_nop 0
    v_cndmask_b32 v7, v8, v7, vcc
    v_lshlrev_b32 v24, 3, v2
    v_sub_u32 v24, v1, v24
    v_mov_b32 v25, 0x3f80
    v_mov_b32 v26, 0x3f800000
    v_cmp_eq_u32 vcc, 0, v24
    v_cmp_eq_u32 s[56:57], 1, v24
    s_nop 0
    v_cndmask_b32 v72, 0, v25, vcc
    v_cndmask_b32 v72, v72, v26, s[56:57]
    v_cmp_eq_u32 vcc, 2, v24
    v_cmp_eq_u32 s[56:57], 3, v24
    s_nop 0
    v_cndmask_b32 v73, 0, v25, vcc
    v_cndmask_b32 v73, v73, v26, s[56:57]
    v_cmp_eq_u32 vcc, 4, v24
    v_cmp_eq_u32 s[56:57], 5, v24
    s_nop 0
    v_cndmask_b32 v74, 0, v25, vcc
    v_cndmask_b32 v74, v74, v26, s[56:57]
    v_cmp_eq_u32 vcc, 6, v24
    v_cmp_eq_u32 s[56:57], 7, v24
    s_nop 0
    v_cndmask_b32 v75, 0, v25, vcc
    v_cndmask_b32 v75, v75, v26, s[56:57]
    v_lshlrev_b32 v24, 3, v2
    v_sub_u32 v24, v7, v24
    v_mov_b32 v25, 0x3f80
    v_mov_b32 v26, 0x3f800000
    v_cmp_eq_u32 vcc, 0, v24
    v_cmp_eq_u32 s[56:57], 1, v24
    s_nop 0
    v_cndmask_b32 v76, 0, v25, vcc
    v_cndmask_b32 v76, v76, v26, s[56:57]
    v_cmp_eq_u32 vcc, 2, v24
    v_cmp_eq_u32 s[56:57], 3, v24
    s_nop 0
    v_cndmask_b32 v77, 0, v25, vcc
    v_cndmask_b32 v77, v77, v26, s[56:57]
    v_cmp_eq_u32 vcc, 4, v24
    v_cmp_eq_u32 s[56:57], 5, v24
    s_nop 0
    v_cndmask_b32 v78, 0, v25, vcc
    v_cndmask_b32 v78, v78, v26, s[56:57]
    v_cmp_eq_u32 vcc, 6, v24
    v_cmp_eq_u32 s[56:57], 7, v24
    s_nop 0
    v_cndmask_b32 v79, 0, v25, vcc
    v_cndmask_b32 v79, v79, v26, s[56:57]
    v_mov_b32 v80, v72
    v_mov_b32 v81, v73
    v_mov_b32 v82, v74
    v_mov_b32 v83, v75
    v_mov_b32 v84, v76
    v_mov_b32 v85, v77
    v_mov_b32 v86, v78
    v_mov_b32 v87, v79
    v_mov_b32 v88, v72
    v_mov_b32 v89, v73
    v_mov_b32 v90, v74
    v_mov_b32 v91, v75
    v_mov_b32 v92, v76
    v_mov_b32 v93, v77
    v_mov_b32 v94, v78
    v_mov_b32 v95, v79
    v_mov_b32 v96, v72
    v_mov_b32 v97, v73
    v_mov_b32 v98, v74
    v_mov_b32 v99, v75
    v_mov_b32 v100, v76
    v_mov_b32 v101, v77
    v_mov_b32 v102, v78
    v_mov_b32 v103, v79
    v_lshlrev_b32 v20, 8, v2
    v_lshl_add_u32 v20, v1, 4, v20
    v_add_u32 v21, 6144, v20
    v_cmp_gt_u32 vcc, 8, v1
    s_nop 1
    v_cndmask_b32 v21, v11, v21, vcc
    v_add_u32 v22, 7168, v20
    v_add_u32 v23, 128, v21
    v_add_u32 v20, 5120, v20
    s_nop 1
L1_mm:
    s_waitcnt vmcnt(0) lgkmcnt(0)
    v_cndmask_b32 v42, v42, 0, s[46:47]
    v_cndmask_b32 v43, v43, 0, s[46:47]
    v_cndmask_b32 v46, v46, 0, s[46:47]
    v_cndmask_b32 v47, v47, 0, s[46:47]
    v_cndmask_b32 v50, v50, 0, s[46:47]
    v_cndmask_b32 v51, v51, 0, s[46:47]
    v_cndmask_b32 v54, v54, 0, s[46:47]
    v_cndmask_b32 v55, v55, 0, s[46:47]
    v_cndmask_b32 v58, v58, 0, s[46:47]
    v_cndmask_b32 v59, v59, 0, s[46:47]
    v_cndmask_b32 v62, v62, 0, s[46:47]
    v_cndmask_b32 v63, v63, 0, s[46:47]
    v_cndmask_b32 v66, v66, 0, s[46:47]
    v_cndmask_b32 v67, v67, 0, s[46:47]
    v_cndmask_b32 v70, v70, 0, s[46:47]
    v_cndmask_b32 v71, v71, 0, s[46:47]
    v_mfma_f32_16x16x32_bf16 v[104:107], v[40:43], v[72:75], 0
    v_mfma_f32_16x16x32_bf16 v[108:111], v[44:47], v[72:75], 0
    v_mfma_f32_16x16x32_bf16 v[112:115], v[40:43], v[76:79], 0
    v_mfma_f32_16x16x32_bf16 v[116:119], v[44:47], v[76:79], 0
    s_nop 4
    v_cvt_pk_bf16_f32 v24, v104, v105
    v_cvt_pk_bf16_f32 v25, v106, v107
    v_cvt_pk_bf16_f32 v26, v108, v109
    v_cvt_pk_bf16_f32 v27, v110, v111
    buffer_store_dwordx4 v[24:27], v20, s[4:7], s37 offen
    v_cvt_pk_bf16_f32 v28, v112, v113
    v_cvt_pk_bf16_f32 v29, v114, v115
    v_cvt_pk_bf16_f32 v30, v116, v117
    v_cvt_pk_bf16_f32 v31, v118, v119
    buffer_store_dwordx4 v[28:31], v21, s[4:7], s37 offen
    v_mfma_f32_16x16x32_bf16 v[104:107], v[48:51], v[80:83], 0
    v_mfma_f32_16x16x32_bf16 v[108:111], v[52:55], v[80:83], 0
    v_mfma_f32_16x16x32_bf16 v[112:115], v[48:51], v[84:87], 0
    v_mfma_f32_16x16x32_bf16 v[116:119], v[52:55], v[84:87], 0
    s_nop 4
    v_cvt_pk_bf16_f32 v32, v104, v105
    v_cvt_pk_bf16_f32 v33, v106, v107
    v_cvt_pk_bf16_f32 v34, v108, v109
    v_cvt_pk_bf16_f32 v35, v110, v111
    buffer_store_dwordx4 v[32:35], v22, s[4:7], s37 offen
    v_cvt_pk_bf16_f32 v36, v112, v113
    v_cvt_pk_bf16_f32 v37, v114, v115
    v_cvt_pk_bf16_f32 v38, v116, v117
    v_cvt_pk_bf16_f32 v39, v118, v119
    buffer_store_dwordx4 v[36:39], v23, s[4:7], s37 offen
    v_mfma_f32_16x16x32_bf16 v[104:107], v[56:59], v[88:91], 0
    v_mfma_f32_16x16x32_bf16 v[108:111], v[60:63], v[88:91], 0
    v_mfma_f32_16x16x32_bf16 v[112:115], v[56:59], v[92:95], 0
    v_mfma_f32_16x16x32_bf16 v[116:119], v[60:63], v[92:95], 0
    s_nop 4
    v_cvt_pk_bf16_f32 v24, v104, v105
    v_cvt_pk_bf16_f32 v25, v106, v107
    v_cvt_pk_bf16_f32 v26, v108, v109
    v_cvt_pk_bf16_f32 v27, v110, v111
    buffer_store_dwordx4 v[24:27], v20, s[4:7], s38 offen
    v_cvt_pk_bf16_f32 v28, v112, v113
    v_cvt_pk_bf16_f32 v29, v114, v115
    v_cvt_pk_bf16_f32 v30, v116, v117
    v_cvt_pk_bf16_f32 v31, v118, v119
    buffer_store_dwordx4 v[28:31], v21, s[4:7], s38 offen
    v_mfma_f32_16x16x32_bf16 v[104:107], v[64:67], v[96:99], 0
    v_mfma_f32_16x16x32_bf16 v[108:111], v[68:71], v[96:99], 0
    v_mfma_f32_16x16x32_bf16 v[112:115], v[64:67], v[100:103], 0
    v_mfma_f32_16x16x32_bf16 v[116:119], v[68:71], v[100:103], 0
    s_nop 4
    v_cvt_pk_bf16_f32 v32, v104, v105
    v_cvt_pk_bf16_f32 v33, v106, v107
    v_cvt_pk_bf16_f32 v34, v108, v109
    v_cvt_pk_bf16_f32 v35, v110, v111
    buffer_store_dwordx4 v[32:35], v22, s[4:7], s38 offen
    v_cvt_pk_bf16_f32 v36, v112, v113
    v_cvt_pk_bf16_f32 v37, v114, v115
    v_cvt_pk_bf16_f32 v38, v116, v117
    v_cvt_pk_bf16_f32 v39, v118, v119
    buffer_store_dwordx4 v[36:39], v23, s[4:7], s38 offen
    s_nop 1
L1_end:
    s_endpgm
.globl mega_kernel
.p2align 8
.type mega_kernel,@function
mega_kernel:
    s_cmp_ge_u32 s2, 256
    s_cbranch_scc1 LM_end
    s_load_dwordx2 s[4:5], s[0:1], 96
    s_load_dwordx2 s[32:33], s[0:1], 0
    s_load_dwordx2 s[36:37], s[0:1], 80
    s_load_dwordx2 s[40:41], s[0:1], 40
    s_load_dwordx2 s[44:45], s[0:1], 48
    s_load_dwordx2 s[48:49], s[0:1], 56
    s_mov_b32 s6, 268435456
    s_mov_b32 s7, 0x20000
    s_mov_b32 s34, 2621440
    s_mov_b32 s35, 0x20000
    s_mov_b32 s38, 2621440
    s_mov_b32 s39, 0x20000
    s_mov_b32 s42, 2211840
    s_mov_b32 s43, 0x20000
    s_mov_b32 s46, 2211840
    s_mov_b32 s47, 0x20000
    s_mov_b32 s50, 2211840
    s_mov_b32 s51, 0x20000
    v_mov_b32 v250, v0
    v_lshrrev_b32 v1, 6, v0
    s_nop 0
    v_readfirstlane_b32 s8, v1
    v_and_b32 v0, 63, v0
    v_lshlrev_b32 v1, 4, v0
    s_lshl_b32 s9, s8, 10
    v_lshlrev_b32 v8, 4, v250
    v_mov_b32 v9, 1.0
    v_cmp_lt_u32 vcc, 159, v250
    s_nop 1
    v_cndmask_b32 v9, 0, v9, vcc
    s_bfe_u32 s10, s2, 0x20001
    s_lshl_b32 s10, s10, 2
    s_bfe_u32 s11, s2, 0x20003
    s_add_u32 s10, s10, s11
    s_and_b32 s11, s2, 1
    s_lshl_b32 s11, s11, 3
    s_lshr_b32 s12, s2, 5
    s_add_u32 s11, s11, s12
    s_and_b32 s28, s8, 1
    s_lshr_b32 s29, s8, 1
    s_lshl_b32 s17, s28, 13
    v_add_u32 v2, s17, v1
    v_add_u32 v3, 0x10000, v2
    s_lshl_b32 s12, s11, 3
    s_add_u32 s13, s12, s8
    s_xor_b32 s17, s8, 1
    s_add_u32 s17, s12, s17
    s_mul_i32 s18, s28, 10240
    s_add_u32 s18, s18, 2621440
    s_mul_i32 s12, s13, 20480
    s_add_u32 s12, s12, s18
    s_mul_i32 s13, s17, 20480
    s_add_u32 s13, s13, s18
    s_mul_i32 s15, s10, 163840
    s_add_u32 s15, s15, s9
    s_add_u32 s15, s15, 5242880
    s_mov_b32 s14, 0x3fb8aa3b
    v_lshrrev_b32 v4, 4, v0
    v_lshlrev_b32 v4, 5, v4
    s_mul_i32 s17, s28, 1280
    v_add_u32 v4, s17, v4
    v_add_u32 v4, 98304, v4
    s_waitcnt lgkmcnt(0)
    s_cmp_ge_u32 s8, 5
    s_cbranch_scc1 L2_nomod
    s_mov_b32 s17, 0
    buffer_load_dwordx4 v[12:15], v8, s[4:7], s17 offen sc1
    s_mov_b32 s17, 15360
    buffer_load_dwordx4 v[16:19], v8, s[4:7], s17 offen sc1
    s_mov_b32 s17, 30720
    buffer_load_dwordx4 v[20:23], v8, s[4:7], s17 offen sc1
    s_mov_b32 s17, 46080
    buffer_load_dwordx4 v[24:27], v8, s[4:7], s17 offen sc1
L2_nomod:
    s_add_u32 m0, s9, 0
    s_nop 0
    buffer_load_dwordx4 v1, s[4:7], s15 offen sc1 lds
    s_add_u32 s15, s15, 8192
    s_add_u32 m0, s9, 8192
    s_nop 0
    buffer_load_dwordx4 v1, s[4:7], s15 offen sc1 lds
    s_add_u32 s15, s15, 8192
    buffer_load_dwordx4 v[60:63], v1, s[4:7], s12 offen offset:0
    buffer_load_dwordx4 v[64:67], v1, s[4:7], s13 offen offset:0
    s_add_u32 m0, s9, 16384
    s_nop 0
    buffer_load_dwordx4 v1, s[4:7], s15 offen sc1 lds
    s_add_u32 s15, s15, 8192
    s_add_u32 m0, s9, 24576
    s_nop 0
    buffer_load_dwordx4 v1, s[4:7], s15 offen sc1 lds
    s_add_u32 s15, s15, 8192
    buffer_load_dwordx4 v[68:71], v1, s[4:7], s12 offen offset:1024
    buffer_load_dwordx4 v[72:75], v1, s[4:7], s13 offen offset:1024
    s_add_u32 m0, s9, 32768
    s_nop 0
    buffer_load_dwordx4 v1, s[4:7], s15 offen sc1 lds
    s_add_u32 s15, s15, 8192
    s_add_u32 m0, s9, 40960
    s_nop 0
    buffer_load_dwordx4 v1, s[4:7], s15 offen sc1 lds
    s_add_u32 s15, s15, 8192
    buffer_load_dwordx4 v[76:79], v1, s[4:7], s12 offen offset:2048
    buffer_load_dwordx4 v[80:83], v1, s[4:7], s13 offen offset:2048
    s_and_b32 s24, s2, 7
    s_lshl_b32 s24, s24, 2
    s_lshr_b32 s17, s2, 6
    s_add_u32 s24, s24, s17
    s_bfe_u32 s25, s2, 0x30003
    s_and_b32 s26, s2, 1
    s_lshl_b32 s26, s26, 2
    s_bfe_u32 s17, s2, 0x20003
    s_add_u32 s26, s26, s17
    s_bfe_u32 s27, s2, 0x20001
    s_lshl_b32 s27, s27, 3
    s_lshr_b32 s17, s2, 5
    s_add_u32 s27, s27, s17
    s_lshr_b32 s52, s8, 2
    s_and_b32 s53, s8, 3
    s_lshl_b32 s30, s24, 2
    s_add_u32 s30, s30, s53
    s_mul_i32 s31, s30, 20480
    s_cmp_lt_u32 s2, 160
    s_cselect_b32 s54, 0, 160
    s_cselect_b32 s55, 3, 1
    s_cselect_b32 s62, 7, 1
    s_sub_u32 s54, s2, s54
    s_lshr_b32 s55, s54, s55
    s_and_b32 s54, s54, s62
    s_mul_i32 s59, s25, 160
    s_add_u32 s59, s59, s31
    s_cmp_ge_u32 s8, 3
    s_cselect_b32 s60, 1, 0
    s_mul_i32 s61, s60, 3
    s_sub_u32 s61, s8, s61
    v_and_b32 v240, 15, v0
    v_lshrrev_b32 v241, 4, v0
    v_lshrrev_b32 v242, 2, v240
    v_and_b32 v243, 3, v240
    v_lshl_add_u32 v244, v242, 3, v243
    v_mul_u32_u24 v246, 1280, v240
    v_lshl_add_u32 v247, v241, 3, v246
    v_lshl_add_u32 v246, v241, 4, v246
    v_lshrrev_b32 v248, 1, v241
    v_lshlrev_b32 v248, 8, v248
    v_lshl_add_u32 v248, v240, 4, v248
    v_and_b32 v249, 1, v241
    v_lshl_add_u32 v248, v249, 3, v248
    s_mul_i32 s17, s52, 5120
    v_add_u32 v251, s17, v1
    v_add_u32 v252, 0x10000, v251
    v_add_u32 v254, 0x10000, v1
    v_add_u32 v255, 0x20000, v1
    v_lshlrev_b32 v249, 4, v240
    v_lshl_add_u32 v249, v241, 2, v249
    s_cmp_ge_u32 s8, 5
    s_nop 0
    s_cbranch_scc1 L2_nomod2
    s_waitcnt vmcnt(12)
    v_add_f32 v12, v12, v16
    v_add_f32 v13, v13, v17
    v_add_f32 v14, v14, v18
    v_add_f32 v15, v15, v19
    v_add_f32 v20, v20, v24
    v_add_f32 v21, v21, v25
    v_add_f32 v22, v22, v26
    v_add_f32 v23, v23, v27
    v_add_f32 v12, v12, v20
    v_add_f32 v13, v13, v21
    v_add_f32 v14, v14, v22
    v_add_f32 v15, v15, v23
    v_cvt_pk_bf16_f32 v16, v12, v13
    v_cvt_pk_bf16_f32 v17, v14, v15
    v_lshlrev_b32 v12, 16, v16
    v_and_b32 v13, 0xffff0000, v16
    v_lshlrev_b32 v14, 16, v17
    v_and_b32 v15, 0xffff0000, v17
    v_add_f32 v12, v9, v12
    v_add_f32 v13, v9, v13
    v_add_f32 v14, v9, v14
    v_add_f32 v15, v9, v15
    v_cvt_pk_bf16_f32 v16, v12, v13
    v_cvt_pk_bf16_f32 v17, v14, v15
    v_lshlrev_b32 v12, 16, v16
    v_and_b32 v13, 0xffff0000, v16
    v_lshlrev_b32 v14, 16, v17
    v_and_b32 v15, 0xffff0000, v17
    v_add_u32 v8, 98304, v8
    ds_write_b128 v8, v[12:15]
    s_nop 0
L2_nomod2:
    s_waitcnt vmcnt(8) lgkmcnt(0)
    s_barrier
    ds_read_b128 v[12:15], v4 offset:0
    ds_read_b128 v[16:19], v4 offset:16
    ds_read_b128 v[20:23], v4 offset:2560
    ds_read_b128 v[24:27], v4 offset:2576
    ds_read_b128 v[28:31], v4 offset:128
    ds_read_b128 v[32:35], v4 offset:144
    ds_read_b128 v[36:39], v4 offset:2688
    ds_read_b128 v[40:43], v4 offset:2704
    ds_read_b128 v[108:111], v2 offset:0
    ds_read_b128 v[112:115], v2 offset:1024
    ds_read_b128 v[116:119], v2 offset:2048
    ds_read_b128 v[120:123], v2 offset:3072
    ds_read_b128 v[124:127], v2 offset:4096
    ds_read_b128 v[128:131], v2 offset:5120
    ds_read_b128 v[132:135], v2 offset:6144
    ds_read_b128 v[136:139], v2 offset:7168
    s_waitcnt lgkmcnt(12)
    v_fma_mix_f32 v44, v60, v20, v12 op_sel_hi:[1,0,0]
    v_fma_mix_f32 v45, v60, v21, v13 op_sel:[1,0,0] op_sel_hi:[1,0,0]
    v_fma_mix_f32 v46, v61, v22, v14 op_sel_hi:[1,0,0]
    v_fma_mix_f32 v47, v61, v23, v15 op_sel:[1,0,0] op_sel_hi:[1,0,0]
    v_cvt_pk_bf16_f32 v60, v44, v45
    v_cvt_pk_bf16_f32 v61, v46, v47
    v_fma_mix_f32 v52, v62, v24, v16 op_sel_hi:[1,0,0]
    v_fma_mix_f32 v53, v62, v25, v17 op_sel:[1,0,0] op_sel_hi:[1,0,0]
    v_fma_mix_f32 v54, v63, v26, v18 op_sel_hi:[1,0,0]
    v_fma_mix_f32 v55, v63, v27, v19 op_sel:[1,0,0] op_sel_hi:[1,0,0]
    v_cvt_pk_bf16_f32 v62, v52, v53
    v_cvt_pk_bf16_f32 v63, v54, v55
    v_fma_mix_f32 v44, v64, v20, v12 op_sel_hi:[1,0,0]
    v_fma_mix_f32 v45, v64, v21, v13 op_sel:[1,0,0] op_sel_hi:[1,0,0]
    v_fma_mix_f32 v46, v65, v22, v14 op_sel_hi:[1,0,0]
    v_fma_mix_f32 v47, v65, v23, v15 op_sel:[1,0,0] op_sel_hi:[1,0,0]
    v_cvt_pk_bf16_f32 v64, v44, v45
    v_cvt_pk_bf16_f32 v65, v46, v47
    v_fma_mix_f32 v52, v66, v24, v16 op_sel_hi:[1,0,0]
    v_fma_mix_f32 v53, v66, v25, v17 op_sel:[1,0,0] op_sel_hi:[1,0,0]
    v_fma_mix_f32 v54, v67, v26, v18 op_sel_hi:[1,0,0]
    v_fma_mix_f32 v55, v67, v27, v19 op_sel:[1,0,0] op_sel_hi:[1,0,0]
    v_cvt_pk_bf16_f32 v66, v52, v53
    v_cvt_pk_bf16_f32 v67, v54, v55
    s_waitcnt vmcnt(4)
    s_barrier
    s_waitcnt lgkmcnt(7)
    v_mfma_f32_16x16x32_bf16 v[172:175], v[108:111], v[60:63], 0
    ds_read_b128 v[140:143], v2 offset:16384
    v_mfma_f32_16x16x32_bf16 v[204:207], v[108:111], v[64:67], 0
    s_add_u32 m0, s9, 49152
    s_nop 0
    buffer_load_dwordx4 v1, s[4:7], s15 offen sc1 lds
    s_add_u32 s15, s15, 8192
    s_waitcnt lgkmcnt(7)
    v_mfma_f32_16x16x32_bf16 v[176:179], v[112:115], v[60:63], 0
    ds_read_b128 v[144:147], v2 offset:17408
    v_mfma_f32_16x16x32_bf16 v[208:211], v[112:115], v[64:67], 0
    s_add_u32 m0, s9, 57344
    s_nop 0
    buffer_load_dwordx4 v1, s[4:7], s15 offen sc1 lds
    s_add_u32 s15, s15, 8192
    v_fma_mix_f32 v44, v68, v36, v28 op_sel_hi:[1,0,0]
    v_fma_mix_f32 v45, v68, v37, v29 op_sel:[1,0,0] op_sel_hi:[1,0,0]
    v_fma_mix_f32 v46, v69, v38, v30 op_sel_hi:[1,0,0]
    v_fma_mix_f32 v47, v69, v39, v31 op_sel:[1,0,0] op_sel_hi:[1,0,0]
    v_cvt_pk_bf16_f32 v68, v44, v45
    v_cvt_pk_bf16_f32 v69, v46, v47
    s_waitcnt lgkmcnt(7)
    v_mfma_f32_16x16x32_bf16 v[180:183], v[116:119], v[60:63], 0
    ds_read_b128 v[148:151], v2 offset:18432
    v_mfma_f32_16x16x32_bf16 v[212:215], v[116:119], v[64:67], 0
    s_add_u32 m0, s9, 65536
    s_nop 0
    buffer_load_dwordx4 v1, s[4:7], s15 offen sc1 lds
    s_add_u32 s15, s15, 8192
    s_waitcnt lgkmcnt(7)
    v_mfma_f32_16x16x32_bf16 v[184:187], v[120:123], v[60:63], 0
    ds_read_b128 v[152:155], v2 offset:19456
    v_fma_mix_f32 v52, v70, v40, v32 op_sel_hi:[1,0,0]
    v_fma_mix_f32 v53, v70, v41, v33 op_sel:[1,0,0] op_sel_hi:[1,0,0]
    v_fma_mix_f32 v54, v71, v42, v34 op_sel_hi:[1,0,0]
    v_fma_mix_f32 v55, v71, v43, v35 op_sel:[1,0,0] op_sel_hi:[1,0,0]
    v_cvt_pk_bf16_f32 v70, v52, v53
    v_cvt_pk_bf16_f32 v71, v54, v55
    v_mfma_f32_16x16x32_bf16 v[216:219], v[120:123], v[64:67], 0
    s_add_u32 m0, s9, 73728
    s_nop 0
    buffer_load_dwordx4 v1, s[4:7], s15 offen sc1 lds
    s_add_u32 s15, s15, 8192
    s_waitcnt lgkmcnt(7)
    v_mfma_f32_16x16x32_bf16 v[188:191], v[124:127], v[60:63], 0
    ds_read_b128 v[156:159], v2 offset:20480
    v_fma_mix_f32 v44, v72, v36, v28 op_sel_hi:[1,0,0]
    v_fma_mix_f32 v45, v72, v37, v29 op_sel:[1,0,0] op_sel_hi:[1,0,0]
    v_fma_mix_f32 v46, v73, v38, v30 op_sel_hi:[1,0,0]
    v_fma_mix_f32 v47, v73, v39, v31 op_sel:[1,0,0] op_sel_hi:[1,0,0]
    v_cvt_pk_bf16_f32 v72, v44, v45
    v_cvt_pk_bf16_f32 v73, v46, v47
    v_mfma_f32_16x16x32_bf16 v[220:223], v[124:127], v[64:67], 0
    buffer_load_dwordx4 v[84:87], v1, s[4:7], s12 offen offset:3072
    s_add_u32 s12, s12, 4096
    s_waitcnt lgkmcnt(7)
    v_mfma_f32_16x16x32_bf16 v[192:195], v[60:63], v[128:131], 0
    ds_read_b128 v[160:163], v2 offset:21504
    v_mfma_f32_16x16x32_bf16 v[224:227], v[64:67], v[128:131], 0
    buffer_load_dwordx4 v[88:91], v1, s[4:7], s13 offen offset:3072
    s_add_u32 s13, s13, 4096
    v_fma_mix_f32 v52, v74, v40, v32 op_sel_hi:[1,0,0]
    v_fma_mix_f32 v53, v74, v41, v33 op_sel:[1,0,0] op_sel_hi:[1,0,0]
    v_fma_mix_f32 v54, v75, v42, v34 op_sel_hi:[1,0,0]
    v_fma_mix_f32 v55, v75, v43, v35 op_sel:[1,0,0] op_sel_hi:[1,0,0]
    v_cvt_pk_bf16_f32 v74, v52, v53
    v_cvt_pk_bf16_f32 v75, v54, v55
    s_waitcnt lgkmcnt(7)
    v_mfma_f32_16x16x32_bf16 v[196:199], v[60:63], v[132:135], 0
    ds_read_b128 v[164:167], v2 offset:22528
    ds_read_b128 v[12:15], v4 offset:256
    v_mfma_f32_16x16x32_bf16 v[228:231], v[64:67], v[132:135], 0
    buffer_load_dwordx4 v[92:95], v1, s[4:7], s12 offen offset:0
    ds_read_b128 v[16:19], v4 offset:272
    s_waitcnt lgkmcnt(9)
    v_mfma_f32_16x16x32_bf16 v[200:203], v[60:63], v[136:139], 0
    ds_read_b128 v[168:171], v2 offset:23552
    ds_read_b128 v[20:23], v4 offset:2816
    v_mfma_f32_16x16x32_bf16 v[232:235], v[64:67], v[136:139], 0
    buffer_load_dwordx4 v[96:99], v1, s[4:7], s13 offen offset:0
    ds_read_b128 v[24:27], v4 offset:2832
    s_waitcnt vmcnt(8)
    s_barrier
    s_waitcnt lgkmcnt(11)
    v_mfma_f32_16x16x32_bf16 v[172:175], v[140:143], v[68:71], v[172:175]
    ds_read_b128 v[108:111], v2 offset:32768
    v_mfma_f32_16x16x32_bf16 v[204:207], v[140:143], v[72:75], v[204:207]
    s_add_u32 m0, s9, 81920
    s_nop 0
    buffer_load_dwordx4 v1, s[4:7], s15 offen sc1 lds
    s_add_u32 s15, s15, 8192
    s_waitcnt lgkmcnt(1)
    v_mfma_f32_16x16x32_bf16 v[176:179], v[144:147], v[68:71], v[176:179]
    ds_read_b128 v[112:115], v2 offset:33792
    v_mfma_f32_16x16x32_bf16 v[208:211], v[144:147], v[72:75], v[208:211]
    v_fma_mix_f32 v44, v76, v20, v12 op_sel_hi:[1,0,0]
    v_fma_mix_f32 v45, v76, v21, v13 op_sel:[1,0,0] op_sel_hi:[1,0,0]
    v_fma_mix_f32 v46, v77, v22, v14 op_sel_hi:[1,0,0]
    v_fma_mix_f32 v47, v77, v23, v15 op_sel:[1,0,0] op_sel_hi:[1,0,0]
    v_cvt_pk_bf16_f32 v76, v44, v45
    v_cvt_pk_bf16_f32 v77, v46, v47
    v_mfma_f32_16x16x32_bf16 v[180:183], v[148:151], v[68:71], v[180:183]
    ds_read_b128 v[116:119], v2 offset:34816
    v_mfma_f32_16x16x32_bf16 v[212:215], v[148:151], v[72:75], v[212:215]
    s_add_u32 m0, s9, 90112
    s_nop 0
    buffer_load_dwordx4 v1, s[4:7], s15 offen sc1 lds
    s_add_u32 s15, s15, 8192
    v_mfma_f32_16x16x32_bf16 v[184:187], v[152:155], v[68:71], v[184:187]
    ds_read_b128 v[120:123], v2 offset:35840
    v_fma_mix_f32 v52, v78, v24, v16 op_sel_hi:[1,0,0]
    v_fma_mix_f32 v53, v78, v25, v17 op_sel:[1,0,0] op_sel_hi:[1,0,0]
    v_fma_mix_f32 v54, v79, v26, v18 op_sel_hi:[1,0,0]
    v_fma_mix_f32 v55, v79, v27, v19 op_sel:[1,0,0] op_sel_hi:[1,0,0]
    v_cvt_pk_bf16_f32 v78, v52, v53
    v_cvt_pk_bf16_f32 v79, v54, v55
    v_mfma_f32_16x16x32_bf16 v[216:219], v[152:155], v[72:75], v[216:219]
    v_mfma_f32_16x16x32_bf16 v[188:191], v[156:159], v[68:71], v[188:191]
    ds_read_b128 v[124:127], v2 offset:36864
    v_fma_mix_f32 v44, v80, v20, v12 op_sel_hi:[1,0,0]
    v_fma_mix_f32 v45, v80, v21, v13 op_sel:[1,0,0] op_sel_hi:[1,0,0]
    v_fma_mix_f32 v46, v81, v22, v14 op_sel_hi:[1,0,0]
    v_fma_mix_f32 v47, v81, v23, v15 op_sel:[1,0,0] op_sel_hi:[1,0,0]
    v_cvt_pk_bf16_f32 v80, v44, v45
    v_cvt_pk_bf16_f32 v81, v46, v47
    v_mfma_f32_16x16x32_bf16 v[220:223], v[156:159], v[72:75], v[220:223]
    buffer_load_dwordx4 v[100:103], v1, s[4:7], s12 offen offset:1024
    v_mfma_f32_16x16x32_bf16 v[192:195], v[68:71], v[160:163], v[192:195]
    ds_read_b128 v[128:131], v2 offset:37888
    v_mfma_f32_16x16x32_bf16 v[224:227], v[72:75], v[160:163], v[224:227]
    v_fma_mix_f32 v52, v82, v24, v16 op_sel_hi:[1,0,0]
    v_fma_mix_f32 v53, v82, v25, v17 op_sel:[1,0,0] op_sel_hi:[1,0,0]
    v_fma_mix_f32 v54, v83, v26, v18 op_sel_hi:[1,0,0]
    v_fma_mix_f32 v55, v83, v27, v19 op_sel:[1,0,0] op_sel_hi:[1,0,0]
    v_cvt_pk_bf16_f32 v82, v52, v53
    v_cvt_pk_bf16_f32 v83, v54, v55
    v_mfma_f32_16x16x32_bf16 v[196:199], v[68:71], v[164:167], v[196:199]
    ds_read_b128 v[132:135], v2 offset:38912
    ds_read_b128 v[28:31], v4 offset:384
    v_mfma_f32_16x16x32_bf16 v[228:231], v[72:75], v[164:167], v[228:231]
    buffer_load_dwordx4 v[104:107], v1, s[4:7], s13 offen offset:1024
    ds_read_b128 v[32:35], v4 offset:400
    v_mfma_f32_16x16x32_bf16 v[200:203], v[68:71], v[168:171], v[200:203]
    ds_read_b128 v[136:139], v2 offset:39936
    ds_read_b128 v[36:39], v4 offset:2944
    v_mfma_f32_16x16x32_bf16 v[232:235], v[72:75], v[168:171], v[232:235]
    ds_read_b128 v[40:43], v4 offset:2960
    s_waitcnt vmcnt(6)
    s_barrier
    s_waitcnt lgkmcnt(11)
    v_mfma_f32_16x16x32_bf16 v[172:175], v[108:111], v[76:79], v[172:175]
    ds_read_b128 v[140:143], v2 offset:49152
    v_mfma_f32_16x16x32_bf16 v[204:207], v[108:111], v[80:83], v[204:207]
    s_add_u32 m0, s9, 0
    s_nop 0
    buffer_load_dwordx4 v1, s[4:7], s15 offen sc1 lds
    s_add_u32 s15, s15, 8192
    s_waitcnt lgkmcnt(1)
    v_mfma_f32_16x16x32_bf16 v[176:179], v[112:115], v[76:79], v[176:179]
    ds_read_b128 v[144:147], v2 offset:50176
    v_mfma_f32_16x16x32_bf16 v[208:211], v[112:115], v[80:83], v[208:211]
    v_fma_mix_f32 v44, v84, v36, v28 op_sel_hi:[1,0,0]
    v_fma_mix_f32 v45, v84, v37, v29 op_sel:[1,0,0] op_sel_hi:[1,0,0]
    v_fma_mix_f32 v46, v85, v38, v30 op_sel_hi:[1,0,0]
    v_fma_mix_f32 v47, v85, v39, v31 op_sel:[1,0,0] op_sel_hi:[1,0,0]
    v_cvt_pk_bf16_f32 v84, v44, v45
    v_cvt_pk_bf16_f32 v85, v46, v47
    v_mfma_f32_16x16x32_bf16 v[180:183], v[116:119], v[76:79], v[180:183]
    ds_read_b128 v[148:151], v2 offset:51200
    v_mfma_f32_16x16x32_bf16 v[212:215], v[116:119], v[80:83], v[212:215]
    s_add_u32 m0, s9, 8192
    s_nop 0
    buffer_load_dwordx4 v1, s[4:7], s15 offen sc1 lds
    s_add_u32 s15, s15, 8192
    v_mfma_f32_16x16x32_bf16 v[184:187], v[120:123], v[76:79], v[184:187]
    ds_read_b128 v[152:155], v2 offset:52224
    v_fma_mix_f32 v52, v86, v40, v32 op_sel_hi:[1,0,0]
    v_fma_mix_f32 v53, v86, v41, v33 op_sel:[1,0,0] op_sel_hi:[1,0,0]
    v_fma_mix_f32 v54, v87, v42, v34 op_sel_hi:[1,0,0]
    v_fma_mix_f32 v55, v87, v43, v35 op_sel:[1,0,0] op_sel_hi:[1,0,0]
    v_cvt_pk_bf16_f32 v86, v52, v53
    v_cvt_pk_bf16_f32 v87, v54, v55
    v_mfma_f32_16x16x32_bf16 v[216:219], v[120:123], v[80:83], v[216:219]
    v_mfma_f32_16x16x32_bf16 v[188:191], v[124:127], v[76:79], v[188:191]
    ds_read_b128 v[156:159], v2 offset:53248
    v_fma_mix_f32 v44, v88, v36, v28 op_sel_hi:[1,0,0]
    v_fma_mix_f32 v45, v88, v37, v29 op_sel:[1,0,0] op_sel_hi:[1,0,0]
    v_fma_mix_f32 v46, v89, v38, v30 op_sel_hi:[1,0,0]
    v_fma_mix_f32 v47, v89, v39, v31 op_sel:[1,0,0] op_sel_hi:[1,0,0]
    v_cvt_pk_bf16_f32 v88, v44, v45
    v_cvt_pk_bf16_f32 v89, v46, v47
    v_mfma_f32_16x16x32_bf16 v[220:223], v[124:127], v[80:83], v[220:223]
    buffer_load_dwordx4 v[60:63], v1, s[4:7], s12 offen offset:2048
    v_mfma_f32_16x16x32_bf16 v[192:195], v[76:79], v[128:131], v[192:195]
    ds_read_b128 v[160:163], v2 offset:54272
    v_mfma_f32_16x16x32_bf16 v[224:227], v[80:83], v[128:131], v[224:227]
    v_fma_mix_f32 v52, v90, v40, v32 op_sel_hi:[1,0,0]
    v_fma_mix_f32 v53, v90, v41, v33 op_sel:[1,0,0] op_sel_hi:[1,0,0]
    v_fma_mix_f32 v54, v91, v42, v34 op_sel_hi:[1,0,0]
    v_fma_mix_f32 v55, v91, v43, v35 op_sel:[1,0,0] op_sel_hi:[1,0,0]
    v_cvt_pk_bf16_f32 v90, v52, v53
    v_cvt_pk_bf16_f32 v91, v54, v55
    v_mfma_f32_16x16x32_bf16 v[196:199], v[76:79], v[132:135], v[196:199]
    ds_read_b128 v[164:167], v2 offset:55296
    ds_read_b128 v[12:15], v4 offset:512
    v_mfma_f32_16x16x32_bf16 v[228:231], v[80:83], v[132:135], v[228:231]
    buffer_load_dwordx4 v[64:67], v1, s[4:7], s13 offen offset:2048
    ds_read_b128 v[16:19], v4 offset:528
    v_mfma_f32_16x16x32_bf16 v[200:203], v[76:79], v[136:139], v[200:203]
    ds_read_b128 v[168:171], v2 offset:56320
    ds_read_b128 v[20:23], v4 offset:3072
    v_mfma_f32_16x16x32_bf16 v[232:235], v[80:83], v[136:139], v[232:235]
    ds_read_b128 v[24:27], v4 offset:3088
    s_waitcnt vmcnt(8)
    s_barrier
    s_waitcnt lgkmcnt(11)
    v_mfma_f32_16x16x32_bf16 v[172:175], v[140:143], v[84:87], v[172:175]
    ds_read_b128 v[108:111], v3 offset:0
    v_mfma_f32_16x16x32_bf16 v[204:207], v[140:143], v[88:91], v[204:207]
    s_add_u32 m0, s9, 16384
    s_nop 0
    buffer_load_dwordx4 v1, s[4:7], s15 offen sc1 lds
    s_add_u32 s15, s15, 8192
    s_waitcnt lgkmcnt(1)
    v_mfma_f32_16x16x32_bf16 v[176:179], v[144:147], v[84:87], v[176:179]
    ds_read_b128 v[112:115], v3 offset:1024
    v_mfma_f32_16x16x32_bf16 v[208:211], v[144:147], v[88:91], v[208:211]
    v_fma_mix_f32 v44, v92, v20, v12 op_sel_hi:[1,0,0]
    v_fma_mix_f32 v45, v92, v21, v13 op_sel:[1,0,0] op_sel_hi:[1,0,0]
    v_fma_mix_f32 v46, v93, v22, v14 op_sel_hi:[1,0,0]
    v_fma_mix_f32 v47, v93, v23, v15 op_sel:[1,0,0] op_sel_hi:[1,0,0]
    v_cvt_pk_bf16_f32 v92, v44, v45
    v_cvt_pk_bf16_f32 v93, v46, v47
    v_mfma_f32_16x16x32_bf16 v[180:183], v[148:151], v[84:87], v[180:183]
    ds_read_b128 v[116:119], v3 offset:2048
    v_mfma_f32_16x16x32_bf16 v[212:215], v[148:151], v[88:91], v[212:215]
    s_add_u32 m0, s9, 24576
    s_nop 0
    buffer_load_dwordx4 v1, s[4:7], s15 offen sc1 lds
    s_add_u32 s15, s15, 8192
    v_mfma_f32_16x16x32_bf16 v[184:187], v[152:155], v[84:87], v[184:187]
    ds_read_b128 v[120:123], v3 offset:3072
    v_fma_mix_f32 v52, v94, v24, v16 op_sel_hi:[1,0,0]
    v_fma_mix_f32 v53, v94, v25, v17 op_sel:[1,0,0] op_sel_hi:[1,0,0]
    v_fma_mix_f32 v54, v95, v26, v18 op_sel_hi:[1,0,0]
    v_fma_mix_f32 v55, v95, v27, v19 op_sel:[1,0,0] op_sel_hi:[1,0,0]
    v_cvt_pk_bf16_f32 v94, v52, v53
    v_cvt_pk_bf16_f32 v95, v54, v55
    v_mfma_f32_16x16x32_bf16 v[216:219], v[152:155], v[88:91], v[216:219]
    v_mfma_f32_16x16x32_bf16 v[188:191], v[156:159], v[84:87], v[188:191]
    ds_read_b128 v[124:127], v3 offset:4096
    v_fma_mix_f32 v44, v96, v20, v12 op_sel_hi:[1,0,0]
    v_fma_mix_f32 v45, v96, v21, v13 op_sel:[1,0,0] op_sel_hi:[1,0,0]
    v_fma_mix_f32 v46, v97, v22, v14 op_sel_hi:[1,0,0]
    v_fma_mix_f32 v47, v97, v23, v15 op_sel:[1,0,0] op_sel_hi:[1,0,0]
    v_cvt_pk_bf16_f32 v96, v44, v45
    v_cvt_pk_bf16_f32 v97, v46, v47
    v_mfma_f32_16x16x32_bf16 v[220:223], v[156:159], v[88:91], v[220:223]
    buffer_load_dwordx4 v[68:71], v1, s[4:7], s12 offen offset:3072
    s_add_u32 s12, s12, 4096
    v_mfma_f32_16x16x32_bf16 v[192:195], v[84:87], v[160:163], v[192:195]
    ds_read_b128 v[128:131], v3 offset:5120
    v_mfma_f32_16x16x32_bf16 v[224:227], v[88:91], v[160:163], v[224:227]
    v_fma_mix_f32 v52, v98, v24, v16 op_sel_hi:[1,0,0]
    v_fma_mix_f32 v53, v98, v25, v17 op_sel:[1,0,0] op_sel_hi:[1,0,0]
    v_fma_mix_f32 v54, v99, v26, v18 op_sel_hi:[1,0,0]
    v_fma_mix_f32 v55, v99, v27, v19 op_sel:[1,0,0] op_sel_hi:[1,0,0]
    v_cvt_pk_bf16_f32 v98, v52, v53
    v_cvt_pk_bf16_f32 v99, v54, v55
    v_mfma_f32_16x16x32_bf16 v[196:199], v[84:87], v[164:167], v[196:199]
    ds_read_b128 v[132:135], v3 offset:6144
    ds_read_b128 v[28:31], v4 offset:640
    v_mfma_f32_16x16x32_bf16 v[228:231], v[88:91], v[164:167], v[228:231]
    buffer_load_dwordx4 v[72:75], v1, s[4:7], s13 offen offset:3072
    s_add_u32 s13, s13, 4096
    ds_read_b128 v[32:35], v4 offset:656
    v_mfma_f32_16x16x32_bf16 v[200:203], v[84:87], v[168:171], v[200:203]
    ds_read_b128 v[136:139], v3 offset:7168
    ds_read_b128 v[36:39], v4 offset:3200
    v_mfma_f32_16x16x32_bf16 v[232:235], v[88:91], v[168:171], v[232:235]
    ds_read_b128 v[40:43], v4 offset:3216
    s_waitcnt vmcnt(8)
    s_barrier
    s_waitcnt lgkmcnt(11)
    v_mfma_f32_16x16x32_bf16 v[172:175], v[108:111], v[92:95], v[172:175]
    ds_read_b128 v[140:143], v3 offset:16384
    v_mfma_f32_16x16x32_bf16 v[204:207], v[108:111], v[96:99], v[204:207]
    s_add_u32 m0, s9, 32768
    s_nop 0
    buffer_load_dwordx4 v1, s[4:7], s15 offen sc1 lds
    s_add_u32 s15, s15, 8192
    s_waitcnt lgkmcnt(1)
    v_mfma_f32_16x16x32_bf16 v[176:179], v[112:115], v[92:95], v[176:179]
    ds_read_b128 v[144:147], v3 offset:17408
    v_mfma_f32_16x16x32_bf16 v[208:211], v[112:115], v[96:99], v[208:211]
    v_fma_mix_f32 v44, v100, v36, v28 op_sel_hi:[1,0,0]
    v_fma_mix_f32 v45, v100, v37, v29 op_sel:[1,0,0] op_sel_hi:[1,0,0]
    v_fma_mix_f32 v46, v101, v38, v30 op_sel_hi:[1,0,0]
    v_fma_mix_f32 v47, v101, v39, v31 op_sel:[1,0,0] op_sel_hi:[1,0,0]
    v_cvt_pk_bf16_f32 v100, v44, v45
    v_cvt_pk_bf16_f32 v101, v46, v47
    v_mfma_f32_16x16x32_bf16 v[180:183], v[116:119], v[92:95], v[180:183]
    ds_read_b128 v[148:151], v3 offset:18432
    v_mfma_f32_16x16x32_bf16 v[212:215], v[116:119], v[96:99], v[212:215]
    s_add_u32 m0, s9, 40960
    s_nop 0
    buffer_load_dwordx4 v1, s[4:7], s15 offen sc1 lds
    s_add_u32 s15, s15, 8192
    v_mfma_f32_16x16x32_bf16 v[184:187], v[120:123], v[92:95], v[184:187]
    ds_read_b128 v[152:155], v3 offset:19456
    v_fma_mix_f32 v52, v102, v40, v32 op_sel_hi:[1,0,0]
    v_fma_mix_f32 v53, v102, v41, v33 op_sel:[1,0,0] op_sel_hi:[1,0,0]
    v_fma_mix_f32 v54, v103, v42, v34 op_sel_hi:[1,0,0]
    v_fma_mix_f32 v55, v103, v43, v35 op_sel:[1,0,0] op_sel_hi:[1,0,0]
    v_cvt_pk_bf16_f32 v102, v52, v53
    v_cvt_pk_bf16_f32 v103, v54, v55
    v_mfma_f32_16x16x32_bf16 v[216:219], v[120:123], v[96:99], v[216:219]
    v_mfma_f32_16x16x32_bf16 v[188:191], v[124:127], v[92:95], v[188:191]
    ds_read_b128 v[156:159], v3 offset:20480
    v_fma_mix_f32 v44, v104, v36, v28 op_sel_hi:[1,0,0]
    v_fma_mix_f32 v45, v104, v37, v29 op_sel:[1,0,0] op_sel_hi:[1,0,0]
    v_fma_mix_f32 v46, v105, v38, v30 op_sel_hi:[1,0,0]
    v_fma_mix_f32 v47, v105, v39, v31 op_sel:[1,0,0] op_sel_hi:[1,0,0]
    v_cvt_pk_bf16_f32 v104, v44, v45
    v_cvt_pk_bf16_f32 v105, v46, v47
    v_mfma_f32_16x16x32_bf16 v[220:223], v[124:127], v[96:99], v[220:223]
    buffer_load_dwordx4 v[76:79], v1, s[4:7], s12 offen offset:0
    v_mfma_f32_16x16x32_bf16 v[192:195], v[92:95], v[128:131], v[192:195]
    ds_read_b128 v[160:163], v3 offset:21504
    v_mfma_f32_16x16x32_bf16 v[224:227], v[96:99], v[128:131], v[224:227]
    v_fma_mix_f32 v52, v106, v40, v32 op_sel_hi:[1,0,0]
    v_fma_mix_f32 v53, v106, v41, v33 op_sel:[1,0,0] op_sel_hi:[1,0,0]
    v_fma_mix_f32 v54, v107, v42, v34 op_sel_hi:[1,0,0]
    v_fma_mix_f32 v55, v107, v43, v35 op_sel:[1,0,0] op_sel_hi:[1,0,0]
    v_cvt_pk_bf16_f32 v106, v52, v53
    v_cvt_pk_bf16_f32 v107, v54, v55
    v_mfma_f32_16x16x32_bf16 v[196:199], v[92:95], v[132:135], v[196:199]
    ds_read_b128 v[164:167], v3 offset:22528
    ds_read_b128 v[12:15], v4 offset:768
    v_mfma_f32_16x16x32_bf16 v[228:231], v[96:99], v[132:135], v[228:231]
    buffer_load_dwordx4 v[80:83], v1, s[4:7], s13 offen offset:0
    ds_read_b128 v[16:19], v4 offset:784
    v_mfma_f32_16x16x32_bf16 v[200:203], v[92:95], v[136:139], v[200:203]
    ds_read_b128 v[168:171], v3 offset:23552
    ds_read_b128 v[20:23], v4 offset:3328
    v_mfma_f32_16x16x32_bf16 v[232:235], v[96:99], v[136:139], v[232:235]
    ds_read_b128 v[24:27], v4 offset:3344
    s_waitcnt vmcnt(8)
    s_barrier
    s_waitcnt lgkmcnt(11)
    v_mfma_f32_16x16x32_bf16 v[172:175], v[140:143], v[100:103], v[172:175]
    ds_read_b128 v[108:111], v2 offset:0
    v_mfma_f32_16x16x32_bf16 v[204:207], v[140:143], v[104:107], v[204:207]
    s_add_u32 m0, s9, 49152
    s_nop 0
    buffer_load_dwordx4 v1, s[4:7], s15 offen sc1 lds
    s_add_u32 s15, s15, 8192
    s_waitcnt lgkmcnt(1)
    v_mfma_f32_16x16x32_bf16 v[176:179], v[144:147], v[100:103], v[176:179]
    ds_read_b128 v[112:115], v2 offset:1024
    v_mfma_f32_16x16x32_bf16 v[208:211], v[144:147], v[104:107], v[208:211]
    v_fma_mix_f32 v44, v60, v20, v12 op_sel_hi:[1,0,0]
    v_fma_mix_f32 v45, v60, v21, v13 op_sel:[1,0,0] op_sel_hi:[1,0,0]
    v_fma_mix_f32 v46, v61, v22, v14 op_sel_hi:[1,0,0]
    v_fma_mix_f32 v47, v61, v23, v15 op_sel:[1,0,0] op_sel_hi:[1,0,0]
    v_cvt_pk_bf16_f32 v60, v44, v45
    v_cvt_pk_bf16_f32 v61, v46, v47
    v_mfma_f32_16x16x32_bf16 v[180:183], v[148:151], v[100:103], v[180:183]
    ds_read_b128 v[116:119], v2 offset:2048
    v_mfma_f32_16x16x32_bf16 v[212:215], v[148:151], v[104:107], v[212:215]
    s_add_u32 m0, s9, 57344
    s_nop 0
    buffer_load_dwordx4 v1, s[4:7], s15 offen sc1 lds
    s_add_u32 s15, s15, 8192
    v_mfma_f32_16x16x32_bf16 v[184:187], v[152:155], v[100:103], v[184:187]
    ds_read_b128 v[120:123], v2 offset:3072
    v_fma_mix_f32 v52, v62, v24, v16 op_sel_hi:[1,0,0]
    v_fma_mix_f32 v53, v62, v25, v17 op_sel:[1,0,0] op_sel_hi:[1,0,0]
    v_fma_mix_f32 v54, v63, v26, v18 op_sel_hi:[1,0,0]
    v_fma_mix_f32 v55, v63, v27, v19 op_sel:[1,0,0] op_sel_hi:[1,0,0]
    v_cvt_pk_bf16_f32 v62, v52, v53
    v_cvt_pk_bf16_f32 v63, v54, v55
    v_mfma_f32_16x16x32_bf16 v[216:219], v[152:155], v[104:107], v[216:219]
    v_mfma_f32_16x16x32_bf16 v[188:191], v[156:159], v[100:103], v[188:191]
    ds_read_b128 v[124:127], v2 offset:4096
    v_fma_mix_f32 v44, v64, v20, v12 op_sel_hi:[1,0,0]
    v_fma_mix_f32 v45, v64, v21, v13 op_sel:[1,0,0] op_sel_hi:[1,0,0]
    v_fma_mix_f32 v46, v65, v22, v14 op_sel_hi:[1,0,0]
    v_fma_mix_f32 v47, v65, v23, v15 op_sel:[1,0,0] op_sel_hi:[1,0,0]
    v_cvt_pk_bf16_f32 v64, v44, v45
    v_cvt_pk_bf16_f32 v65, v46, v47
    v_mfma_f32_16x16x32_bf16 v[220:223], v[156:159], v[104:107], v[220:223]
    buffer_load_dwordx4 v[84:87], v1, s[4:7], s12 offen offset:1024
    v_mfma_f32_16x16x32_bf16 v[192:195], v[100:103], v[160:163], v[192:195]
    ds_read_b128 v[128:131], v2 offset:5120
    v_mfma_f32_16x16x32_bf16 v[224:227], v[104:107], v[160:163], v[224:227]
    v_fma_mix_f32 v52, v66, v24, v16 op_sel_hi:[1,0,0]
    v_fma_mix_f32 v53, v66, v25, v17 op_sel:[1,0,0] op_sel_hi:[1,0,0]
    v_fma_mix_f32 v54, v67, v26, v18 op_sel_hi:[1,0,0]
    v_fma_mix_f32 v55, v67, v27, v19 op_sel:[1,0,0] op_sel_hi:[1,0,0]
    v_cvt_pk_bf16_f32 v66, v52, v53
    v_cvt_pk_bf16_f32 v67, v54, v55
    v_mfma_f32_16x16x32_bf16 v[196:199], v[100:103], v[164:167], v[196:199]
    ds_read_b128 v[132:135], v2 offset:6144
    ds_read_b128 v[28:31], v4 offset:896
    v_mfma_f32_16x16x32_bf16 v[228:231], v[104:107], v[164:167], v[228:231]
    buffer_load_dwordx4 v[88:91], v1, s[4:7], s13 offen offset:1024
    ds_read_b128 v[32:35], v4 offset:912
    v_mfma_f32_16x16x32_bf16 v[200:203], v[100:103], v[168:171], v[200:203]
    ds_read_b128 v[136:139], v2 offset:7168
    ds_read_b128 v[36:39], v4 offset:3456
    v_mfma_f32_16x16x32_bf16 v[232:235], v[104:107], v[168:171], v[232:235]
    ds_read_b128 v[40:43], v4 offset:3472
    s_waitcnt vmcnt(8)
    s_barrier
    s_waitcnt lgkmcnt(11)
    v_mfma_f32_16x16x32_bf16 v[172:175], v[108:111], v[60:63], v[172:175]
    ds_read_b128 v[140:143], v2 offset:16384
    v_mfma_f32_16x16x32_bf16 v[204:207], v[108:111], v[64:67], v[204:207]
    s_waitcnt lgkmcnt(1)
    v_mfma_f32_16x16x32_bf16 v[176:179], v[112:115], v[60:63], v[176:179]
    ds_read_b128 v[144:147], v2 offset:17408
    v_mfma_f32_16x16x32_bf16 v[208:211], v[112:115], v[64:67], v[208:211]
    v_fma_mix_f32 v44, v68, v36, v28 op_sel_hi:[1,0,0]
    v_fma_mix_f32 v45, v68, v37, v29 op_sel:[1,0,0] op_sel_hi:[1,0,0]
    v_fma_mix_f32 v46, v69, v38, v30 op_sel_hi:[1,0,0]
    v_fma_mix_f32 v47, v69, v39, v31 op_sel:[1,0,0] op_sel_hi:[1,0,0]
    v_cvt_pk_bf16_f32 v68, v44, v45
    v_cvt_pk_bf16_f32 v69, v46, v47
    v_mfma_f32_16x16x32_bf16 v[180:183], v[116:119], v[60:63], v[180:183]
    ds_read_b128 v[148:151], v2 offset:18432
    v_mfma_f32_16x16x32_bf16 v[212:215], v[116:119], v[64:67], v[212:215]
    v_mfma_f32_16x16x32_bf16 v[184:187], v[120:123], v[60:63], v[184:187]
    ds_read_b128 v[152:155], v2 offset:19456
    v_fma_mix_f32 v52, v70, v40, v32 op_sel_hi:[1,0,0]
    v_fma_mix_f32 v53, v70, v41, v33 op_sel:[1,0,0] op_sel_hi:[1,0,0]
    v_fma_mix_f32 v54, v71, v42, v34 op_sel_hi:[1,0,0]
    v_fma_mix_f32 v55, v71, v43, v35 op_sel:[1,0,0] op_sel_hi:[1,0,0]
    v_cvt_pk_bf16_f32 v70, v52, v53
    v_cvt_pk_bf16_f32 v71, v54, v55
    v_mfma_f32_16x16x32_bf16 v[216:219], v[120:123], v[64:67], v[216:219]
    v_mfma_f32_16x16x32_bf16 v[188:191], v[124:127], v[60:63], v[188:191]
    ds_read_b128 v[156:159], v2 offset:20480
    v_fma_mix_f32 v44, v72, v36, v28 op_sel_hi:[1,0,0]
    v_fma_mix_f32 v45, v72, v37, v29 op_sel:[1,0,0] op_sel_hi:[1,0,0]
    v_fma_mix_f32 v46, v73, v38, v30 op_sel_hi:[1,0,0]
    v_fma_mix_f32 v47, v73, v39, v31 op_sel:[1,0,0] op_sel_hi:[1,0,0]
    v_cvt_pk_bf16_f32 v72, v44, v45
    v_cvt_pk_bf16_f32 v73, v46, v47
    v_mfma_f32_16x16x32_bf16 v[220:223], v[124:127], v[64:67], v[220:223]
    v_mfma_f32_16x16x32_bf16 v[192:195], v[60:63], v[128:131], v[192:195]
    ds_read_b128 v[160:163], v2 offset:21504
    v_mfma_f32_16x16x32_bf16 v[224:227], v[64:67], v[128:131], v[224:227]
    v_fma_mix_f32 v52, v74, v40, v32 op_sel_hi:[1,0,0]
    v_fma_mix_f32 v53, v74, v41, v33 op_sel:[1,0,0] op_sel_hi:[1,0,0]
    v_fma_mix_f32 v54, v75, v42, v34 op_sel_hi:[1,0,0]
    v_fma_mix_f32 v55, v75, v43, v35 op_sel:[1,0,0] op_sel_hi:[1,0,0]
    v_cvt_pk_bf16_f32 v74, v52, v53
    v_cvt_pk_bf16_f32 v75, v54, v55
    v_mfma_f32_16x16x32_bf16 v[196:199], v[60:63], v[132:135], v[196:199]
    ds_read_b128 v[164:167], v2 offset:22528
    ds_read_b128 v[12:15], v4 offset:1024
    v_mfma_f32_16x16x32_bf16 v[228:231], v[64:67], v[132:135], v[228:231]
    ds_read_b128 v[16:19], v4 offset:1040
    v_mfma_f32_16x16x32_bf16 v[200:203], v[60:63], v[136:139], v[200:203]
    ds_read_b128 v[168:171], v2 offset:23552
    ds_read_b128 v[20:23], v4 offset:3584
    v_mfma_f32_16x16x32_bf16 v[232:235], v[64:67], v[136:139], v[232:235]
    ds_read_b128 v[24:27], v4 offset:3600
    s_waitcnt vmcnt(4)
    s_barrier
    s_waitcnt lgkmcnt(11)
    v_mfma_f32_16x16x32_bf16 v[172:175], v[140:143], v[68:71], v[172:175]
    ds_read_b128 v[108:111], v2 offset:32768
    v_mfma_f32_16x16x32_bf16 v[204:207], v[140:143], v[72:75], v[204:207]
    s_waitcnt lgkmcnt(1)
    v_mfma_f32_16x16x32_bf16 v[176:179], v[144:147], v[68:71], v[176:179]
    ds_read_b128 v[112:115], v2 offset:33792
    v_mfma_f32_16x16x32_bf16 v[208:211], v[144:147], v[72:75], v[208:211]
    v_fma_mix_f32 v44, v76, v20, v12 op_sel_hi:[1,0,0]
    v_fma_mix_f32 v45, v76, v21, v13 op_sel:[1,0,0] op_sel_hi:[1,0,0]
    v_fma_mix_f32 v46, v77, v22, v14 op_sel_hi:[1,0,0]
    v_fma_mix_f32 v47, v77, v23, v15 op_sel:[1,0,0] op_sel_hi:[1,0,0]
    v_cvt_pk_bf16_f32 v76, v44, v45
    v_cvt_pk_bf16_f32 v77, v46, v47
    v_mfma_f32_16x16x32_bf16 v[180:183], v[148:151], v[68:71], v[180:183]
    ds_read_b128 v[116:119], v2 offset:34816
    v_mfma_f32_16x16x32_bf16 v[212:215], v[148:151], v[72:75], v[212:215]
    v_mfma_f32_16x16x32_bf16 v[184:187], v[152:155], v[68:71], v[184:187]
    ds_read_b128 v[120:123], v2 offset:35840
    v_fma_mix_f32 v52, v78, v24, v16 op_sel_hi:[1,0,0]
    v_fma_mix_f32 v53, v78, v25, v17 op_sel:[1,0,0] op_sel_hi:[1,0,0]
    v_fma_mix_f32 v54, v79, v26, v18 op_sel_hi:[1,0,0]
    v_fma_mix_f32 v55, v79, v27, v19 op_sel:[1,0,0] op_sel_hi:[1,0,0]
    v_cvt_pk_bf16_f32 v78, v52, v53
    v_cvt_pk_bf16_f32 v79, v54, v55
    v_mfma_f32_16x16x32_bf16 v[216:219], v[152:155], v[72:75], v[216:219]
    v_mfma_f32_16x16x32_bf16 v[188:191], v[156:159], v[68:71], v[188:191]
    ds_read_b128 v[124:127], v2 offset:36864
    v_fma_mix_f32 v44, v80, v20, v12 op_sel_hi:[1,0,0]
    v_fma_mix_f32 v45, v80, v21, v13 op_sel:[1,0,0] op_sel_hi:[1,0,0]
    v_fma_mix_f32 v46, v81, v22, v14 op_sel_hi:[1,0,0]
    v_fma_mix_f32 v47, v81, v23, v15 op_sel:[1,0,0] op_sel_hi:[1,0,0]
    v_cvt_pk_bf16_f32 v80, v44, v45
    v_cvt_pk_bf16_f32 v81, v46, v47
    v_mfma_f32_16x16x32_bf16 v[220:223], v[156:159], v[72:75], v[220:223]
    v_mfma_f32_16x16x32_bf16 v[192:195], v[68:71], v[160:163], v[192:195]
    ds_read_b128 v[128:131], v2 offset:37888
    v_mfma_f32_16x16x32_bf16 v[224:227], v[72:75], v[160:163], v[224:227]
    v_fma_mix_f32 v52, v82, v24, v16 op_sel_hi:[1,0,0]
    v_fma_mix_f32 v53, v82, v25, v17 op_sel:[1,0,0] op_sel_hi:[1,0,0]
    v_fma_mix_f32 v54, v83, v26, v18 op_sel_hi:[1,0,0]
    v_fma_mix_f32 v55, v83, v27, v19 op_sel:[1,0,0] op_sel_hi:[1,0,0]
    v_cvt_pk_bf16_f32 v82, v52, v53
    v_cvt_pk_bf16_f32 v83, v54, v55
    v_mfma_f32_16x16x32_bf16 v[196:199], v[68:71], v[164:167], v[196:199]
    ds_read_b128 v[132:135], v2 offset:38912
    ds_read_b128 v[28:31], v4 offset:1152
    v_mfma_f32_16x16x32_bf16 v[228:231], v[72:75], v[164:167], v[228:231]
    ds_read_b128 v[32:35], v4 offset:1168
    v_mfma_f32_16x16x32_bf16 v[200:203], v[68:71], v[168:171], v[200:203]
    ds_read_b128 v[136:139], v2 offset:39936
    ds_read_b128 v[36:39], v4 offset:3712
    v_mfma_f32_16x16x32_bf16 v[232:235], v[72:75], v[168:171], v[232:235]
    ds_read_b128 v[40:43], v4 offset:3728
    s_waitcnt vmcnt(0)
    s_barrier
    s_waitcnt lgkmcnt(11)
    v_mfma_f32_16x16x32_bf16 v[172:175], v[108:111], v[76:79], v[172:175]
    ds_read_b128 v[140:143], v2 offset:49152
    v_mfma_f32_16x16x32_bf16 v[204:207], v[108:111], v[80:83], v[204:207]
    s_waitcnt lgkmcnt(1)
    v_mfma_f32_16x16x32_bf16 v[176:179], v[112:115], v[76:79], v[176:179]
    ds_read_b128 v[144:147], v2 offset:50176
    v_mfma_f32_16x16x32_bf16 v[208:211], v[112:115], v[80:83], v[208:211]
    v_fma_mix_f32 v44, v84, v36, v28 op_sel_hi:[1,0,0]
    v_fma_mix_f32 v45, v84, v37, v29 op_sel:[1,0,0] op_sel_hi:[1,0,0]
    v_fma_mix_f32 v46, v85, v38, v30 op_sel_hi:[1,0,0]
    v_fma_mix_f32 v47, v85, v39, v31 op_sel:[1,0,0] op_sel_hi:[1,0,0]
    v_cvt_pk_bf16_f32 v84, v44, v45
    v_cvt_pk_bf16_f32 v85, v46, v47
    v_mfma_f32_16x16x32_bf16 v[180:183], v[116:119], v[76:79], v[180:183]
    ds_read_b128 v[148:151], v2 offset:51200
    v_mfma_f32_16x16x32_bf16 v[212:215], v[116:119], v[80:83], v[212:215]
    v_mfma_f32_16x16x32_bf16 v[184:187], v[120:123], v[76:79], v[184:187]
    ds_read_b128 v[152:155], v2 offset:52224
    v_fma_mix_f32 v52, v86, v40, v32 op_sel_hi:[1,0,0]
    v_fma_mix_f32 v53, v86, v41, v33 op_sel:[1,0,0] op_sel_hi:[1,0,0]
    v_fma_mix_f32 v54, v87, v42, v34 op_sel_hi:[1,0,0]
    v_fma_mix_f32 v55, v87, v43, v35 op_sel:[1,0,0] op_sel_hi:[1,0,0]
    v_cvt_pk_bf16_f32 v86, v52, v53
    v_cvt_pk_bf16_f32 v87, v54, v55
    v_mfma_f32_16x16x32_bf16 v[216:219], v[120:123], v[80:83], v[216:219]
    v_mfma_f32_16x16x32_bf16 v[188:191], v[124:127], v[76:79], v[188:191]
    ds_read_b128 v[156:159], v2 offset:53248
    v_fma_mix_f32 v44, v88, v36, v28 op_sel_hi:[1,0,0]
    v_fma_mix_f32 v45, v88, v37, v29 op_sel:[1,0,0] op_sel_hi:[1,0,0]
    v_fma_mix_f32 v46, v89, v38, v30 op_sel_hi:[1,0,0]
    v_fma_mix_f32 v47, v89, v39, v31 op_sel:[1,0,0] op_sel_hi:[1,0,0]
    v_cvt_pk_bf16_f32 v88, v44, v45
    v_cvt_pk_bf16_f32 v89, v46, v47
    v_mfma_f32_16x16x32_bf16 v[220:223], v[124:127], v[80:83], v[220:223]
    v_mfma_f32_16x16x32_bf16 v[192:195], v[76:79], v[128:131], v[192:195]
    ds_read_b128 v[160:163], v2 offset:54272
    v_mfma_f32_16x16x32_bf16 v[224:227], v[80:83], v[128:131], v[224:227]
    v_fma_mix_f32 v52, v90, v40, v32 op_sel_hi:[1,0,0]
    v_fma_mix_f32 v53, v90, v41, v33 op_sel:[1,0,0] op_sel_hi:[1,0,0]
    v_fma_mix_f32 v54, v91, v42, v34 op_sel_hi:[1,0,0]
    v_fma_mix_f32 v55, v91, v43, v35 op_sel:[1,0,0] op_sel_hi:[1,0,0]
    v_cvt_pk_bf16_f32 v90, v52, v53
    v_cvt_pk_bf16_f32 v91, v54, v55
    v_mfma_f32_16x16x32_bf16 v[196:199], v[76:79], v[132:135], v[196:199]
    ds_read_b128 v[164:167], v2 offset:55296
    v_mfma_f32_16x16x32_bf16 v[228:231], v[80:83], v[132:135], v[228:231]
    v_mfma_f32_16x16x32_bf16 v[200:203], v[76:79], v[136:139], v[200:203]
    ds_read_b128 v[168:171], v2 offset:56320
    v_mfma_f32_16x16x32_bf16 v[232:235], v[80:83], v[136:139], v[232:235]
    s_waitcnt lgkmcnt(7)
    v_mfma_f32_16x16x32_bf16 v[172:175], v[140:143], v[84:87], v[172:175]
    v_mfma_f32_16x16x32_bf16 v[204:207], v[140:143], v[88:91], v[204:207]
    s_waitcnt lgkmcnt(6)
    v_mfma_f32_16x16x32_bf16 v[176:179], v[144:147], v[84:87], v[176:179]
    v_mfma_f32_16x16x32_bf16 v[208:211], v[144:147], v[88:91], v[208:211]
    s_waitcnt lgkmcnt(5)
    v_mfma_f32_16x16x32_bf16 v[180:183], v[148:151], v[84:87], v[180:183]
    v_mfma_f32_16x16x32_bf16 v[212:215], v[148:151], v[88:91], v[212:215]
    s_waitcnt lgkmcnt(4)
    v_mfma_f32_16x16x32_bf16 v[184:187], v[152:155], v[84:87], v[184:187]
    v_mfma_f32_16x16x32_bf16 v[216:219], v[152:155], v[88:91], v[216:219]
    s_waitcnt lgkmcnt(3)
    v_mfma_f32_16x16x32_bf16 v[188:191], v[156:159], v[84:87], v[188:191]
    v_mfma_f32_16x16x32_bf16 v[220:223], v[156:159], v[88:91], v[220:223]
    s_waitcnt lgkmcnt(2)
    v_mfma_f32_16x16x32_bf16 v[192:195], v[84:87], v[160:163], v[192:195]
    v_mfma_f32_16x16x32_bf16 v[224:227], v[88:91], v[160:163], v[224:227]
    s_waitcnt lgkmcnt(1)
    v_mfma_f32_16x16x32_bf16 v[196:199], v[84:87], v[164:167], v[196:199]
    v_mfma_f32_16x16x32_bf16 v[228:231], v[88:91], v[164:167], v[228:231]
    s_waitcnt lgkmcnt(0)
    v_mfma_f32_16x16x32_bf16 v[200:203], v[84:87], v[168:171], v[200:203]
    v_mfma_f32_16x16x32_bf16 v[232:235], v[88:91], v[168:171], v[232:235]
    s_lshl_b32 s17, s8, 13
    v_add_u32 v5, s17, v1
    s_xor_b32 s17, s17, 0x2000
    v_add_u32 v6, s17, v1
    s_barrier
    ds_write_b128 v5, v[204:207] offset:0
    ds_write_b128 v5, v[208:211] offset:1024
    ds_write_b128 v5, v[212:215] offset:2048
    ds_write_b128 v5, v[216:219] offset:3072
    ds_write_b128 v5, v[220:223] offset:4096
    ds_write_b128 v5, v[224:227] offset:5120
    ds_write_b128 v5, v[228:231] offset:6144
    ds_write_b128 v5, v[232:235] offset:7168
    s_lshl_b32 s17, s8, 2
    v_add_u32 v7, s17, v241
    v_xor_b32 v7, v7, v240
    v_and_b32 v7, 15, v7
    v_lshlrev_b32 v7, 4, v7
    s_cmp_ge_u32 s2, 160
    s_nop 0
    s_cbranch_scc1 LS_ldw
    v_mul_u32_u24 v8, 3456, v241
    v_add_u32 v7, v7, v8
    s_mul_i32 s17, s55, 110592
    s_mul_i32 s18, s54, 448
    s_add_u32 s17, s17, s18
    s_mul_i32 s18, s8, 13824
    s_add_u32 s17, s17, s18
    s_add_u32 m0, s9, 65536
    s_nop 0
    buffer_load_dwordx4 v7, s[40:43], s17 offen offset:0 lds
    s_add_u32 m0, s9, 73472
    s_nop 0
    buffer_load_dwordx4 v7, s[40:43], s17 offen offset:256 lds
    s_add_u32 m0, s9, 81920
    s_nop 0
    buffer_load_dwordx4 v7, s[44:47], s17 offen offset:0 lds
    s_add_u32 m0, s9, 89856
    s_nop 0
    buffer_load_dwordx4 v7, s[44:47], s17 offen offset:256 lds
    s_cmp_lg_u32 s8, 7
    s_cbranch_scc1 LS_ldd0
    v_and_b32 v124, 7, v0
    v_bfe_u32 v125, v0, 3, 1
    v_mul_u32_u24 v126, 160, v125
    v_add_u32 v124, v124, v126
    s_lshl_b32 s17, s55, 3
    s_add_u32 s17, s17, 480
    v_add_u32 v124, s17, v124
    v_lshlrev_b32 v124, 4, v124
    v_cvt_f32_u32 v125, v125
    s_mov_b32 s17, 0
    buffer_load_dwordx4 v[108:111], v124, s[4:7], s17 offen sc1
    s_mov_b32 s17, 15360
    buffer_load_dwordx4 v[112:115], v124, s[4:7], s17 offen sc1
    s_mov_b32 s17, 30720
    buffer_load_dwordx4 v[116:119], v124, s[4:7], s17 offen sc1
    s_mov_b32 s17, 46080
    buffer_load_dwordx4 v[120:123], v124, s[4:7], s17 offen sc1
    s_branch LS_ldd0
LS_ldw:
    v_mul_u32_u24 v8, 1280, v241
    v_add_u32 v7, v7, v8
    s_mul_i32 s17, s55, 40960
    s_mul_i32 s18, s54, 640
    s_add_u32 s17, s17, s18
    s_mul_i32 s18, s8, 5120
    s_add_u32 s17, s17, s18
    s_add_u32 m0, s9, 65536
    s_nop 0
    buffer_load_dwordx4 v7, s[48:51], s17 offen offset:0 lds
    s_add_u32 m0, s9, 73472
    s_nop 0
    buffer_load_dwordx4 v7, s[48:51], s17 offen offset:256 lds
    s_add_u32 m0, s9, 81408
    s_nop 0
    buffer_load_dwordx4 v7, s[48:51], s17 offen offset:512 lds
LS_ldd0:
    v_lshrrev_b32 v8, 5, v0
    s_lshl_b32 s17, s8, 4
    v_add_u32 v10, s17, v240
    v_mul_u32_u24 v10, 176, v10
    v_mul_u32_u24 v11, 80, v8
    v_add_u32 v10, v10, v11
    v_add_u32 v10, 103424, v10
    v_mul_u32_u24 v9, 1280, v8
    v_lshl_add_u32 v9, v240, 4, v9
    s_mul_i32 s17, s8, 2560
    s_add_u32 s17, s17, 138240
    v_add_u32 v9, s17, v9
    s_mul_i32 s17, s29, 3072
    s_lshl_b32 s18, s28, 3
    s_add_u32 s17, s17, s18
    s_add_u32 s17, s17, 125952
    v_add_u32 v11, s17, v1
    v_and_b32 v12, 7, v0
    v_cmp_eq_u32 s[20:21], 4, v12
    v_mov_b32 v13, 0x3f803f80
    s_waitcnt lgkmcnt(0)
    s_barrier
    ds_read_b128 v[16:19], v6 offset:0
    ds_read_b128 v[20:23], v6 offset:1024
    ds_read_b128 v[24:27], v6 offset:2048
    ds_read_b128 v[28:31], v6 offset:3072
    ds_read_b128 v[32:35], v6 offset:4096
    ds_read_b128 v[36:39], v6 offset:5120
    ds_read_b128 v[40:43], v6 offset:6144
    ds_read_b128 v[44:47], v6 offset:7168
    s_waitcnt lgkmcnt(7)
    v_pk_add_f32 v[172:173], v[172:173], v[16:17]
    v_pk_add_f32 v[174:175], v[174:175], v[18:19]
    s_waitcnt lgkmcnt(6)
    v_pk_add_f32 v[176:177], v[176:177], v[20:21]
    v_pk_add_f32 v[178:179], v[178:179], v[22:23]
    s_waitcnt lgkmcnt(5)
    v_pk_add_f32 v[180:181], v[180:181], v[24:25]
    v_pk_add_f32 v[182:183], v[182:183], v[26:27]
    s_waitcnt lgkmcnt(4)
    v_pk_add_f32 v[184:185], v[184:185], v[28:29]
    v_pk_add_f32 v[186:187], v[186:187], v[30:31]
    s_waitcnt lgkmcnt(3)
    v_pk_add_f32 v[188:189], v[188:189], v[32:33]
    v_pk_add_f32 v[190:191], v[190:191], v[34:35]
    s_waitcnt lgkmcnt(2)
    v_pk_add_f32 v[192:193], v[192:193], v[36:37]
    v_pk_add_f32 v[194:195], v[194:195], v[38:39]
    s_waitcnt lgkmcnt(1)
    v_pk_add_f32 v[196:197], v[196:197], v[40:41]
    v_pk_add_f32 v[198:199], v[198:199], v[42:43]
    s_waitcnt lgkmcnt(0)
    v_pk_add_f32 v[200:201], v[200:201], v[44:45]
    v_pk_add_f32 v[202:203], v[202:203], v[46:47]
    v_max3_f32 v14, v172, v173, v174
    v_min3_f32 v15, v172, v173, v174
    v_max3_f32 v16, v175, v176, v177
    v_min3_f32 v17, v175, v176, v177
    v_max3_f32 v14, v14, v178, v179
    v_min3_f32 v15, v15, v178, v179
    v_max3_f32 v16, v16, v180, v181
    v_min3_f32 v17, v17, v180, v181
    v_max3_f32 v14, v14, v182, v183
    v_min3_f32 v15, v15, v182, v183
    v_max3_f32 v16, v16, v184, v185
    v_min3_f32 v17, v17, v184, v185
    v_max3_f32 v14, v14, v186, v187
    v_min3_f32 v15, v15, v186, v187
    v_max3_f32 v16, v16, v188, v189
    v_min3_f32 v17, v17, v188, v189
    v_max3_f32 v14, v14, v190, v191
    v_min3_f32 v15, v15, v190, v191
    v_cvt_pk_bf16_f32 v100, v192, v193
    v_cvt_pk_bf16_f32 v101, v194, v195
    v_cvt_pk_bf16_f32 v102, v196, v197
    v_cvt_pk_bf16_f32 v103, v198, v199
    v_cvt_pk_bf16_f32 v104, v200, v201
    v_cvt_pk_bf16_f32 v105, v202, v203
    v_max_f32 v14, v14, v16
    v_min_f32 v15, v15, v17
    v_cndmask_b32 v102, v102, v13, s[20:21]
    v_cndmask_b32 v103, v103, v13, s[20:21]
    v_mul_f32 v14, s14, v14
    v_mul_f32 v15, s14, v15
    ds_write_b64 v11, v[100:101] offset:0
    ds_write_b64 v11, v[102:103] offset:1024
    ds_write_b64 v11, v[104:105] offset:2048
    s_mov_b32 s22, s14
    s_mov_b32 s23, s14
    v_pk_fma_f32 v[18:19], v[172:173], s[22:23], v[14:15] op_sel_hi:[1,1,0] neg_lo:[0,0,1] neg_hi:[0,0,1]
    v_pk_fma_f32 v[38:39], v[172:173], s[22:23], v[14:15] op_sel:[0,0,1] op_sel_hi:[1,1,1] neg_lo:[1,0,0] neg_hi:[1,0,0]
    v_pk_fma_f32 v[20:21], v[174:175], s[22:23], v[14:15] op_sel_hi:[1,1,0] neg_lo:[0,0,1] neg_hi:[0,0,1]
    v_pk_fma_f32 v[40:41], v[174:175], s[22:23], v[14:15] op_sel:[0,0,1] op_sel_hi:[1,1,1] neg_lo:[1,0,0] neg_hi:[1,0,0]
    v_pk_fma_f32 v[22:23], v[176:177], s[22:23], v[14:15] op_sel_hi:[1,1,0] neg_lo:[0,0,1] neg_hi:[0,0,1]
    v_pk_fma_f32 v[42:43], v[176:177], s[22:23], v[14:15] op_sel:[0,0,1] op_sel_hi:[1,1,1] neg_lo:[1,0,0] neg_hi:[1,0,0]
    v_pk_fma_f32 v[24:25], v[178:179], s[22:23], v[14:15] op_sel_hi:[1,1,0] neg_lo:[0,0,1] neg_hi:[0,0,1]
    v_pk_fma_f32 v[44:45], v[178:179], s[22:23], v[14:15] op_sel:[0,0,1] op_sel_hi:[1,1,1] neg_lo:[1,0,0] neg_hi:[1,0,0]
    v_pk_fma_f32 v[26:27], v[180:181], s[22:23], v[14:15] op_sel_hi:[1,1,0] neg_lo:[0,0,1] neg_hi:[0,0,1]
    v_pk_fma_f32 v[46:47], v[180:181], s[22:23], v[14:15] op_sel:[0,0,1] op_sel_hi:[1,1,1] neg_lo:[1,0,0] neg_hi:[1,0,0]
    v_pk_fma_f32 v[28:29], v[182:183], s[22:23], v[14:15] op_sel_hi:[1,1,0] neg_lo:[0,0,1] neg_hi:[0,0,1]
    v_pk_fma_f32 v[48:49], v[182:183], s[22:23], v[14:15] op_sel:[0,0,1] op_sel_hi:[1,1,1] neg_lo:[1,0,0] neg_hi:[1,0,0]
    v_pk_fma_f32 v[30:31], v[184:185], s[22:23], v[14:15] op_sel_hi:[1,1,0] neg_lo:[0,0,1] neg_hi:[0,0,1]
    v_pk_fma_f32 v[50:51], v[184:185], s[22:23], v[14:15] op_sel:[0,0,1] op_sel_hi:[1,1,1] neg_lo:[1,0,0] neg_hi:[1,0,0]
    v_pk_fma_f32 v[32:33], v[186:187], s[22:23], v[14:15] op_sel_hi:[1,1,0] neg_lo:[0,0,1] neg_hi:[0,0,1]
    v_pk_fma_f32 v[52:53], v[186:187], s[22:23], v[14:15] op_sel:[0,0,1] op_sel_hi:[1,1,1] neg_lo:[1,0,0] neg_hi:[1,0,0]
    v_pk_fma_f32 v[34:35], v[188:189], s[22:23], v[14:15] op_sel_hi:[1,1,0] neg_lo:[0,0,1] neg_hi:[0,0,1]
    v_pk_fma_f32 v[54:55], v[188:189], s[22:23], v[14:15] op_sel:[0,0,1] op_sel_hi:[1,1,1] neg_lo:[1,0,0] neg_hi:[1,0,0]
    v_pk_fma_f32 v[36:37], v[190:191], s[22:23], v[14:15] op_sel_hi:[1,1,0] neg_lo:[0,0,1] neg_hi:[0,0,1]
    v_pk_fma_f32 v[56:57], v[190:191], s[22:23], v[14:15] op_sel:[0,0,1] op_sel_hi:[1,1,1] neg_lo:[1,0,0] neg_hi:[1,0,0]
    v_exp_f32 v18, v18
    v_exp_f32 v19, v19
    v_exp_f32 v20, v20
    v_exp_f32 v21, v21
    v_exp_f32 v22, v22
    v_exp_f32 v23, v23
    v_exp_f32 v24, v24
    v_exp_f32 v25, v25
    v_exp_f32 v26, v26
    v_exp_f32 v27, v27
    v_exp_f32 v28, v28
    v_exp_f32 v29, v29
    v_exp_f32 v30, v30
    v_exp_f32 v31, v31
    v_exp_f32 v32, v32
    v_exp_f32 v33, v33
    v_exp_f32 v34, v34
    v_exp_f32 v35, v35
    v_exp_f32 v36, v36
    v_exp_f32 v37, v37
    v_exp_f32 v38, v38
    v_exp_f32 v39, v39
    v_exp_f32 v40, v40
    v_exp_f32 v41, v41
    v_exp_f32 v42, v42
    v_exp_f32 v43, v43
    v_exp_f32 v44, v44
    v_exp_f32 v45, v45
    v_exp_f32 v46, v46
    v_exp_f32 v47, v47
    v_exp_f32 v48, v48
    v_exp_f32 v49, v49
    v_exp_f32 v50, v50
    v_exp_f32 v51, v51
    v_exp_f32 v52, v52
    v_exp_f32 v53, v53
    v_exp_f32 v54, v54
    v_exp_f32 v55, v55
    v_exp_f32 v56, v56
    v_exp_f32 v57, v57
    v_pk_add_f32 v[58:59], v[18:19], v[20:21]
    v_pk_add_f32 v[60:61], v[38:39], v[40:41]
    v_pk_add_f32 v[62:63], v[22:23], v[24:25]
    v_pk_add_f32 v[64:65], v[42:43], v[44:45]
    v_pk_add_f32 v[58:59], v[58:59], v[26:27]
    v_pk_add_f32 v[60:61], v[60:61], v[46:47]
    v_pk_add_f32 v[62:63], v[62:63], v[28:29]
    v_pk_add_f32 v[64:65], v[64:65], v[48:49]
    v_pk_add_f32 v[58:59], v[58:59], v[30:31]
    v_pk_add_f32 v[60:61], v[60:61], v[50:51]
    v_pk_add_f32 v[62:63], v[62:63], v[32:33]
    v_pk_add_f32 v[64:65], v[64:65], v[52:53]
    v_pk_add_f32 v[58:59], v[58:59], v[34:35]
    v_pk_add_f32 v[60:61], v[60:61], v[54:55]
    v_pk_add_f32 v[62:63], v[62:63], v[36:37]
    v_pk_add_f32 v[64:65], v[64:65], v[56:57]
    v_pk_add_f32 v[58:59], v[58:59], v[62:63]
    v_pk_add_f32 v[60:61], v[60:61], v[64:65]
    v_add_f32 v58, v58, v59
    v_add_f32 v60, v60, v61
    v_rcp_f32 v58, v58
    v_rcp_f32 v60, v60
    v_pk_mul_f32 v[18:19], v[18:19], v[58:59] op_sel_hi:[1,0]
    v_pk_mul_f32 v[20:21], v[20:21], v[58:59] op_sel_hi:[1,0]
    v_pk_mul_f32 v[22:23], v[22:23], v[58:59] op_sel_hi:[1,0]
    v_pk_mul_f32 v[24:25], v[24:25], v[58:59] op_sel_hi:[1,0]
    v_pk_mul_f32 v[26:27], v[26:27], v[58:59] op_sel_hi:[1,0]
    v_pk_mul_f32 v[28:29], v[28:29], v[58:59] op_sel_hi:[1,0]
    v_pk_mul_f32 v[30:31], v[30:31], v[58:59] op_sel_hi:[1,0]
    v_pk_mul_f32 v[32:33], v[32:33], v[58:59] op_sel_hi:[1,0]
    v_pk_mul_f32 v[34:35], v[34:35], v[58:59] op_sel_hi:[1,0]
    v_pk_mul_f32 v[36:37], v[36:37], v[58:59] op_sel_hi:[1,0]
    v_pk_mul_f32 v[38:39], v[38:39], v[60:61] op_sel_hi:[1,0]
    v_pk_mul_f32 v[40:41], v[40:41], v[60:61] op_sel_hi:[1,0]
    v_pk_mul_f32 v[42:43], v[42:43], v[60:61] op_sel_hi:[1,0]
    v_pk_mul_f32 v[44:45], v[44:45], v[60:61] op_sel_hi:[1,0]
    v_pk_mul_f32 v[46:47], v[46:47], v[60:61] op_sel_hi:[1,0]
    v_pk_mul_f32 v[48:49], v[48:49], v[60:61] op_sel_hi:[1,0]
    v_pk_mul_f32 v[50:51], v[50:51], v[60:61] op_sel_hi:[1,0]
    v_pk_mul_f32 v[52:53], v[52:53], v[60:61] op_sel_hi:[1,0]
    v_pk_mul_f32 v[54:55], v[54:55], v[60:61] op_sel_hi:[1,0]
    v_pk_mul_f32 v[56:57], v[56:57], v[60:61] op_sel_hi:[1,0]
    v_cvt_pk_bf16_f32 v68, v18, v19
    v_cvt_pk_bf16_f32 v69, v20, v21
    v_cvt_pk_bf16_f32 v70, v22, v23
    v_cvt_pk_bf16_f32 v71, v24, v25
    v_cvt_pk_bf16_f32 v72, v26, v27
    v_cvt_pk_bf16_f32 v73, v28, v29
    v_cvt_pk_bf16_f32 v74, v30, v31
    v_cvt_pk_bf16_f32 v75, v32, v33
    v_cvt_pk_bf16_f32 v76, v34, v35
    v_cvt_pk_bf16_f32 v77, v36, v37
    v_cvt_pk_bf16_f32 v78, v38, v39
    v_cvt_pk_bf16_f32 v79, v40, v41
    v_cvt_pk_bf16_f32 v80, v42, v43
    v_cvt_pk_bf16_f32 v81, v44, v45
    v_cvt_pk_bf16_f32 v82, v46, v47
    v_cvt_pk_bf16_f32 v83, v48, v49
    v_cvt_pk_bf16_f32 v84, v50, v51
    v_cvt_pk_bf16_f32 v85, v52, v53
    v_cvt_pk_bf16_f32 v86, v54, v55
    v_cvt_pk_bf16_f32 v87, v56, v57
    s_mov_b32 exec_lo, 0xffff0000
    s_mov_b32 exec_hi, 0xffff0000
    ds_write_b128 v10, v[68:71] offset:0
    ds_write_b128 v10, v[72:75] offset:16
    ds_write_b128 v10, v[76:79] offset:32
    ds_write_b128 v10, v[80:83] offset:48
    ds_write_b128 v10, v[84:87] offset:64
    s_mov_b32 exec_lo, 0xffff
    s_mov_b32 exec_hi, 0xffff
    ds_write_b128 v9, v[68:71] offset:0
    ds_write_b128 v9, v[72:75] offset:256
    ds_write_b128 v9, v[76:79] offset:512
    ds_write_b128 v9, v[80:83] offset:768
    ds_write_b128 v9, v[84:87] offset:1024
    s_mov_b64 exec, -1
    v_lshrrev_b32 v8, 2, v0
    v_mul_u32_u24 v8, 176, v8
    v_and_b32 v9, 3, v0
    v_lshl_add_u32 v8, v9, 3, v8
    s_mul_i32 s18, s60, 80
    s_lshl_b32 s19, s61, 5
    s_add_u32 s18, s18, s19
    s_add_u32 s18, s18, 103424
    v_add_u32 v8, s18, v8
    s_lshl_b32 s18, s60, 11
    s_add_u32 s18, s18, 125952
    v_add_u32 v9, s18, v1
    v_add_u32 v10, 126976, v1
    s_lshl_b32 s18, s11, 5
    s_lshl_b32 s19, s10, 1
    s_add_u32 s18, s18, s19
    s_add_u32 s18, s18, s60
    s_mul_i32 s18, s18, 3360
    s_lshl_b32 s19, s61, 6
    s_add_u32 s18, s18, s19
    s_add_u32 s18, s18, 524288
    v_mul_u32_u24 v12, 160, v240
    v_lshl_add_u32 v12, v241, 4, v12
    v_mov_b32 v14, 1073741824
    s_lshl_b32 s19, s61, 2
    v_add_u32 v11, s19, v241
    v_cmp_gt_u32 vcc, 10, v11
    s_nop 1
    v_cndmask_b32 v12, v14, v12, vcc
    s_lshl_b32 s19, s60, 3
    v_subrev_u32 v11, s19, v240
    s_mul_i32 s19, s60, 1280
    s_sub_u32 s19, 2560, s19
    v_add_u32 v13, s19, v12
    v_cmp_gt_u32 vcc, 5, v11
    s_nop 1
    v_cndmask_b32 v13, v14, v13, vcc
    s_waitcnt lgkmcnt(0)
    s_barrier
    s_cmp_ge_u32 s8, 6
    s_cbranch_scc1 L2_nokv
    ds_read_b64_tr_b16 v[16:17], v8 offset:0
    ds_read_b64_tr_b16 v[18:19], v8 offset:2816
    ds_read_b128 v[20:23], v9 offset:0
    ds_read_b128 v[24:27], v10 offset:0
    ds_read_b64_tr_b16 v[28:29], v8 offset:5632
    ds_read_b64_tr_b16 v[30:31], v8 offset:8448
    ds_read_b128 v[32:35], v9 offset:3072
    ds_read_b128 v[36:39], v10 offset:3072
    ds_read_b64_tr_b16 v[40:41], v8 offset:11264
    ds_read_b64_tr_b16 v[42:43], v8 offset:14080
    ds_read_b128 v[44:47], v9 offset:6144
    ds_read_b128 v[48:51], v10 offset:6144
    ds_read_b64_tr_b16 v[52:53], v8 offset:16896
    ds_read_b64_tr_b16 v[54:55], v8 offset:19712
    ds_read_b128 v[56:59], v9 offset:9216
    ds_read_b128 v[60:63], v10 offset:9216
    s_waitcnt lgkmcnt(12)
    v_mfma_f32_16x16x32_bf16 v[92:95], v[16:19], v[20:23], 0
    v_mfma_f32_16x16x32_bf16 v[96:99], v[16:19], v[24:27], 0
    s_waitcnt lgkmcnt(8)
    v_mfma_f32_16x16x32_bf16 v[92:95], v[28:31], v[32:35], v[92:95]
    v_mfma_f32_16x16x32_bf16 v[96:99], v[28:31], v[36:39], v[96:99]
    s_waitcnt lgkmcnt(4)
    v_mfma_f32_16x16x32_bf16 v[92:95], v[40:43], v[44:47], v[92:95]
    v_mfma_f32_16x16x32_bf16 v[96:99], v[40:43], v[48:51], v[96:99]
    s_waitcnt lgkmcnt(0)
    v_mfma_f32_16x16x32_bf16 v[92:95], v[52:55], v[56:59], v[92:95]
    v_mfma_f32_16x16x32_bf16 v[96:99], v[52:55], v[60:63], v[96:99]
    s_nop 6
    buffer_store_dwordx4 v[92:95], v12, s[4:7], s18 offen sc1
    buffer_store_dwordx4 v[96:99], v13, s[4:7], s18 offen sc1
    s_nop 1
L2_nokv:
    s_cmp_ge_u32 s2, 160
    s_cbranch_scc1 LS_sel5
    s_cmp_lg_u32 s8, 7
    s_cbranch_scc1 LS_not7
    s_waitcnt vmcnt(0)
    v_add_f32 v108, v108, v112
    v_add_f32 v109, v109, v113
    v_add_f32 v110, v110, v114
    v_add_f32 v111, v111, v115
    v_add_f32 v116, v116, v120
    v_add_f32 v117, v117, v121
    v_add_f32 v118, v118, v122
    v_add_f32 v119, v119, v123
    v_add_f32 v108, v108, v116
    v_add_f32 v109, v109, v117
    v_add_f32 v110, v110, v118
    v_add_f32 v111, v111, v119
    v_cvt_pk_bf16_f32 v112, v108, v109
    v_cvt_pk_bf16_f32 v113, v110, v111
    v_lshlrev_b32 v108, 16, v112
    v_and_b32 v109, 0xffff0000, v112
    v_lshlrev_b32 v110, 16, v113
    v_and_b32 v111, 0xffff0000, v113
    v_add_f32 v108, v125, v108
    v_add_f32 v109, v125, v109
    v_add_f32 v110, v125, v110
    v_add_f32 v111, v125, v111
    v_cvt_pk_bf16_f32 v112, v108, v109
    v_cvt_pk_bf16_f32 v113, v110, v111
    v_lshlrev_b32 v108, 16, v112
    v_and_b32 v109, 0xffff0000, v112
    v_lshlrev_b32 v110, 16, v113
    v_and_b32 v111, 0xffff0000, v113
    v_add_u32 v124, 160384, v1
    s_mov_b32 exec_lo, 0xffff
    s_mov_b32 exec_hi, 0
    ds_write_b128 v124, v[108:111]
    s_mov_b64 exec, -1
LS_not7:
    s_mul_i32 s17, s29, 7
    s_lshl_b32 s19, s28, 2
    s_add_u32 s17, s17, s19
    v_add_u32 v164, s17, v241
    v_add_u32 v170, 0, v244
    v_xor_b32 v171, v170, v164
    v_and_b32 v171, 15, v171
    v_lshrrev_b32 v164, 4, v164
    v_lshlrev_b32 v164, 13, v164
    v_lshl_add_u32 v164, v170, 8, v164
    v_lshl_add_u32 v164, v171, 4, v164
    v_add_u32 v164, 65536, v164
    v_add_u32 v165, s17, v241
    v_add_u32 v170, 4, v244
    v_xor_b32 v171, v170, v165
    v_and_b32 v171, 15, v171
    v_lshrrev_b32 v165, 4, v165
    v_lshlrev_b32 v165, 13, v165
    v_lshl_add_u32 v165, v170, 8, v165
    v_lshl_add_u32 v165, v171, 4, v165
    v_add_u32 v165, 65536, v165
    s_nop 1
    s_branch LS_seld
LS_sel5:
    s_cmp_ge_u32 s8, 4
    s_cbranch_scc1 LS_seld
    s_mul_i32 s17, s8, 10
    v_add_u32 v160, s17, v241
    v_add_u32 v170, 0, v244
    v_xor_b32 v171, v170, v160
    v_and_b32 v171, 15, v171
    v_lshrrev_b32 v160, 4, v160
    v_lshlrev_b32 v160, 13, v160
    v_lshl_add_u32 v160, v170, 8, v160
    v_lshl_add_u32 v160, v171, 4, v160
    v_add_u32 v160, 65536, v160
    v_add_u32 v161, s17, v241
    v_add_u32 v170, 4, v244
    v_xor_b32 v171, v170, v161
    v_and_b32 v171, 15, v171
    v_lshrrev_b32 v161, 4, v161
    v_lshlrev_b32 v161, 13, v161
    v_lshl_add_u32 v161, v170, 8, v161
    v_lshl_add_u32 v161, v171, 4, v161
    v_add_u32 v161, 65536, v161
    v_add_u32 v162, s17, v241
    v_add_u32 v162, 4, v162
    v_add_u32 v170, 0, v244
    v_xor_b32 v171, v170, v162
    v_and_b32 v171, 15, v171
    v_lshrrev_b32 v162, 4, v162
    v_lshlrev_b32 v162, 13, v162
    v_lshl_add_u32 v162, v170, 8, v162
    v_lshl_add_u32 v162, v171, 4, v162
    v_add_u32 v162, 65536, v162
    v_add_u32 v163, s17, v241
    v_add_u32 v163, 4, v163
    v_add_u32 v170, 4, v244
    v_xor_b32 v171, v170, v163
    v_and_b32 v171, 15, v171
    v_lshrrev_b32 v163, 4, v163
    v_lshlrev_b32 v163, 13, v163
    v_lshl_add_u32 v163, v170, 8, v163
    v_lshl_add_u32 v163, v171, 4, v163
    v_add_u32 v163, 65536, v163
    v_and_b32 v164, 1, v241
    v_add_u32 v164, s17, v164
    v_add_u32 v164, 8, v164
    v_add_u32 v170, 0, v244
    v_xor_b32 v171, v170, v164
    v_and_b32 v171, 15, v171
    v_lshrrev_b32 v164, 4, v164
    v_lshlrev_b32 v164, 13, v164
    v_lshl_add_u32 v164, v170, 8, v164
    v_lshl_add_u32 v164, v171, 4, v164
    v_add_u32 v164, 65536, v164
    v_and_b32 v165, 1, v241
    v_add_u32 v165, s17, v165
    v_add_u32 v165, 8, v165
    v_add_u32 v170, 4, v244
    v_xor_b32 v171, v170, v165
    v_and_b32 v171, 15, v171
    v_lshrrev_b32 v165, 4, v165
    v_lshlrev_b32 v165, 13, v165
    v_lshl_add_u32 v165, v170, 8, v165
    v_lshl_add_u32 v165, v171, 4, v165
    v_add_u32 v165, 65536, v165
    s_nop 1
LS_seld:
    s_cmp_ge_u32 s2, 160
    s_cbranch_scc1 LS_sv5
    v_and_b32 v160, 1, v240
    v_lshl_add_u32 v161, v242, 3, v160
    v_lshl_add_u32 v160, v242, 1, v160
    s_cmp_eq_u32 s28, 0
    s_cselect_b64 vcc, -1, 0
    v_cndmask_b32 v160, v160, v161, vcc
    v_mov_b32 v161, 100
    v_and_b32 v162, 2, v240
    v_cmp_eq_u32 vcc, 0, v162
    s_nop 1
    v_cndmask_b32 v162, v161, v160, vcc
    v_cndmask_b32 v160, v160, v161, vcc
    s_cmp_eq_u32 s28, 0
    s_nop 0
    s_cbranch_scc0 LS_svB
    v_lshlrev_b32 v166, 3, v241
    v_sub_u32 v166, v162, v166
    v_mov_b32 v167, 0x3f80
    v_mov_b32 v168, 0x3f800000
    v_cmp_eq_u32 vcc, 0, v166
    v_cmp_eq_u32 s[56:57], 1, v166
    s_nop 0
    v_cndmask_b32 v128, 0, v167, vcc
    v_cndmask_b32 v128, v128, v168, s[56:57]
    v_cmp_eq_u32 vcc, 2, v166
    v_cmp_eq_u32 s[56:57], 3, v166
    s_nop 0
    v_cndmask_b32 v129, 0, v167, vcc
    v_cndmask_b32 v129, v129, v168, s[56:57]
    v_cmp_eq_u32 vcc, 4, v166
    v_cmp_eq_u32 s[56:57], 5, v166
    s_nop 0
    v_cndmask_b32 v130, 0, v167, vcc
    v_cndmask_b32 v130, v130, v168, s[56:57]
    v_cmp_eq_u32 vcc, 6, v166
    v_cmp_eq_u32 s[56:57], 7, v166
    s_nop 0
    v_cndmask_b32 v131, 0, v167, vcc
    v_cndmask_b32 v131, v131, v168, s[56:57]
    v_cmp_eq_u32 vcc, -2, v166
    v_cmp_eq_u32 s[56:57], -1, v166
    s_nop 0
    v_cndmask_b32 v132, 0, v167, vcc
    v_cndmask_b32 v132, v132, v168, s[56:57]
    v_cmp_eq_u32 vcc, 0, v166
    v_cmp_eq_u32 s[56:57], 1, v166
    s_nop 0
    v_cndmask_b32 v133, 0, v167, vcc
    v_cndmask_b32 v133, v133, v168, s[56:57]
    v_cmp_eq_u32 vcc, 2, v166
    v_cmp_eq_u32 s[56:57], 3, v166
    s_nop 0
    v_cndmask_b32 v134, 0, v167, vcc
    v_cndmask_b32 v134, v134, v168, s[56:57]
    v_cmp_eq_u32 vcc, 4, v166
    v_cmp_eq_u32 s[56:57], 5, v166
    s_nop 0
    v_cndmask_b32 v135, 0, v167, vcc
    v_cndmask_b32 v135, v135, v168, s[56:57]
    v_cmp_eq_u32 vcc, -4, v166
    v_cmp_eq_u32 s[56:57], -3, v166
    s_nop 0
    v_cndmask_b32 v136, 0, v167, vcc
    v_cndmask_b32 v136, v136, v168, s[56:57]
    v_cmp_eq_u32 vcc, -2, v166
    v_cmp_eq_u32 s[56:57], -1, v166
    s_nop 0
    v_cndmask_b32 v137, 0, v167, vcc
    v_cndmask_b32 v137, v137, v168, s[56:57]
    v_cmp_eq_u32 vcc, 0, v166
    v_cmp_eq_u32 s[56:57], 1, v166
    s_nop 0
    v_cndmask_b32 v138, 0, v167, vcc
    v_cndmask_b32 v138, v138, v168, s[56:57]
    v_cmp_eq_u32 vcc, 2, v166
    v_cmp_eq_u32 s[56:57], 3, v166
    s_nop 0
    v_cndmask_b32 v139, 0, v167, vcc
    v_cndmask_b32 v139, v139, v168, s[56:57]
    v_cmp_eq_u32 vcc, -6, v166
    v_cmp_eq_u32 s[56:57], -5, v166
    s_nop 0
    v_cndmask_b32 v140, 0, v167, vcc
    v_cndmask_b32 v140, v140, v168, s[56:57]
    v_cmp_eq_u32 vcc, -4, v166
    v_cmp_eq_u32 s[56:57], -3, v166
    s_nop 0
    v_cndmask_b32 v141, 0, v167, vcc
    v_cndmask_b32 v141, v141, v168, s[56:57]
    v_cmp_eq_u32 vcc, -2, v166
    v_cmp_eq_u32 s[56:57], -1, v166
    s_nop 0
    v_cndmask_b32 v142, 0, v167, vcc
    v_cndmask_b32 v142, v142, v168, s[56:57]
    v_cmp_eq_u32 vcc, 0, v166
    v_cmp_eq_u32 s[56:57], 1, v166
    s_nop 0
    v_cndmask_b32 v143, 0, v167, vcc
    v_cndmask_b32 v143, v143, v168, s[56:57]
    v_lshlrev_b32 v166, 3, v241
    v_sub_u32 v166, v160, v166
    v_mov_b32 v167, 0x3f80
    v_mov_b32 v168, 0x3f800000
    v_cmp_eq_u32 vcc, 0, v166
    v_cmp_eq_u32 s[56:57], 1, v166
    s_nop 0
    v_cndmask_b32 v144, 0, v167, vcc
    v_cndmask_b32 v144, v144, v168, s[56:57]
    v_cmp_eq_u32 vcc, 2, v166
    v_cmp_eq_u32 s[56:57], 3, v166
    s_nop 0
    v_cndmask_b32 v145, 0, v167, vcc
    v_cndmask_b32 v145, v145, v168, s[56:57]
    v_cmp_eq_u32 vcc, 4, v166
    v_cmp_eq_u32 s[56:57], 5, v166
    s_nop 0
    v_cndmask_b32 v146, 0, v167, vcc
    v_cndmask_b32 v146, v146, v168, s[56:57]
    v_cmp_eq_u32 vcc, 6, v166
    v_cmp_eq_u32 s[56:57], 7, v166
    s_nop 0
    v_cndmask_b32 v147, 0, v167, vcc
    v_cndmask_b32 v147, v147, v168, s[56:57]
    v_cmp_eq_u32 vcc, -2, v166
    v_cmp_eq_u32 s[56:57], -1, v166
    s_nop 0
    v_cndmask_b32 v148, 0, v167, vcc
    v_cndmask_b32 v148, v148, v168, s[56:57]
    v_cmp_eq_u32 vcc, 0, v166
    v_cmp_eq_u32 s[56:57], 1, v166
    s_nop 0
    v_cndmask_b32 v149, 0, v167, vcc
    v_cndmask_b32 v149, v149, v168, s[56:57]
    v_cmp_eq_u32 vcc, 2, v166
    v_cmp_eq_u32 s[56:57], 3, v166
    s_nop 0
    v_cndmask_b32 v150, 0, v167, vcc
    v_cndmask_b32 v150, v150, v168, s[56:57]
    v_cmp_eq_u32 vcc, 4, v166
    v_cmp_eq_u32 s[56:57], 5, v166
    s_nop 0
    v_cndmask_b32 v151, 0, v167, vcc
    v_cndmask_b32 v151, v151, v168, s[56:57]
    v_cmp_eq_u32 vcc, -4, v166
    v_cmp_eq_u32 s[56:57], -3, v166
    s_nop 0
    v_cndmask_b32 v152, 0, v167, vcc
    v_cndmask_b32 v152, v152, v168, s[56:57]
    v_cmp_eq_u32 vcc, -2, v166
    v_cmp_eq_u32 s[56:57], -1, v166
    s_nop 0
    v_cndmask_b32 v153, 0, v167, vcc
    v_cndmask_b32 v153, v153, v168, s[56:57]
    v_cmp_eq_u32 vcc, 0, v166
    v_cmp_eq_u32 s[56:57], 1, v166
    s_nop 0
    v_cndmask_b32 v154, 0, v167, vcc
    v_cndmask_b32 v154, v154, v168, s[56:57]
    v_cmp_eq_u32 vcc, 2, v166
    v_cmp_eq_u32 s[56:57], 3, v166
    s_nop 0
    v_cndmask_b32 v155, 0, v167, vcc
    v_cndmask_b32 v155, v155, v168, s[56:57]
    v_cmp_eq_u32 vcc, -6, v166
    v_cmp_eq_u32 s[56:57], -5, v166
    s_nop 0
    v_cndmask_b32 v156, 0, v167, vcc
    v_cndmask_b32 v156, v156, v168, s[56:57]
    v_cmp_eq_u32 vcc, -4, v166
    v_cmp_eq_u32 s[56:57], -3, v166
    s_nop 0
    v_cndmask_b32 v157, 0, v167, vcc
    v_cndmask_b32 v157, v157, v168, s[56:57]
    v_cmp_eq_u32 vcc, -2, v166
    v_cmp_eq_u32 s[56:57], -1, v166
    s_nop 0
    v_cndmask_b32 v158, 0, v167, vcc
    v_cndmask_b32 v158, v158, v168, s[56:57]
    v_cmp_eq_u32 vcc, 0, v166
    v_cmp_eq_u32 s[56:57], 1, v166
    s_nop 0
    v_cndmask_b32 v159, 0, v167, vcc
    v_cndmask_b32 v159, v159, v168, s[56:57]
    s_nop 1
    s_branch LS_svd
LS_svB:
    v_lshlrev_b32 v166, 3, v241
    v_sub_u32 v166, v162, v166
    v_mov_b32 v167, 0x3f80
    v_mov_b32 v168, 0x3f800000
    v_cmp_eq_u32 vcc, 0, v166
    v_cmp_eq_u32 s[56:57], 1, v166
    s_nop 0
    v_cndmask_b32 v128, 0, v167, vcc
    v_cndmask_b32 v128, v128, v168, s[56:57]
    v_cmp_eq_u32 vcc, 2, v166
    v_cmp_eq_u32 s[56:57], 3, v166
    s_nop 0
    v_cndmask_b32 v129, 0, v167, vcc
    v_cndmask_b32 v129, v129, v168, s[56:57]
    v_cmp_eq_u32 vcc, 4, v166
    v_cmp_eq_u32 s[56:57], 5, v166
    s_nop 0
    v_cndmask_b32 v130, 0, v167, vcc
    v_cndmask_b32 v130, v130, v168, s[56:57]
    v_cmp_eq_u32 vcc, 6, v166
    v_cmp_eq_u32 s[56:57], 7, v166
    s_nop 0
    v_cndmask_b32 v131, 0, v167, vcc
    v_cndmask_b32 v131, v131, v168, s[56:57]
    v_cmp_eq_u32 vcc, -8, v166
    v_cmp_eq_u32 s[56:57], -7, v166
    s_nop 0
    v_cndmask_b32 v132, 0, v167, vcc
    v_cndmask_b32 v132, v132, v168, s[56:57]
    v_cmp_eq_u32 vcc, -6, v166
    v_cmp_eq_u32 s[56:57], -5, v166
    s_nop 0
    v_cndmask_b32 v133, 0, v167, vcc
    v_cndmask_b32 v133, v133, v168, s[56:57]
    v_cmp_eq_u32 vcc, -4, v166
    v_cmp_eq_u32 s[56:57], -3, v166
    s_nop 0
    v_cndmask_b32 v134, 0, v167, vcc
    v_cndmask_b32 v134, v134, v168, s[56:57]
    v_cmp_eq_u32 vcc, -2, v166
    v_cmp_eq_u32 s[56:57], -1, v166
    s_nop 0
    v_cndmask_b32 v135, 0, v167, vcc
    v_cndmask_b32 v135, v135, v168, s[56:57]
    v_cmp_eq_u32 vcc, -16, v166
    v_cmp_eq_u32 s[56:57], -15, v166
    s_nop 0
    v_cndmask_b32 v136, 0, v167, vcc
    v_cndmask_b32 v136, v136, v168, s[56:57]
    v_cmp_eq_u32 vcc, -14, v166
    v_cmp_eq_u32 s[56:57], -13, v166
    s_nop 0
    v_cndmask_b32 v137, 0, v167, vcc
    v_cndmask_b32 v137, v137, v168, s[56:57]
    v_cmp_eq_u32 vcc, -12, v166
    v_cmp_eq_u32 s[56:57], -11, v166
    s_nop 0
    v_cndmask_b32 v138, 0, v167, vcc
    v_cndmask_b32 v138, v138, v168, s[56:57]
    v_cmp_eq_u32 vcc, -10, v166
    v_cmp_eq_u32 s[56:57], -9, v166
    s_nop 0
    v_cndmask_b32 v139, 0, v167, vcc
    v_cndmask_b32 v139, v139, v168, s[56:57]
    v_lshlrev_b32 v166, 3, v241
    v_sub_u32 v166, v160, v166
    v_mov_b32 v167, 0x3f80
    v_mov_b32 v168, 0x3f800000
    v_cmp_eq_u32 vcc, 0, v166
    v_cmp_eq_u32 s[56:57], 1, v166
    s_nop 0
    v_cndmask_b32 v144, 0, v167, vcc
    v_cndmask_b32 v144, v144, v168, s[56:57]
    v_cmp_eq_u32 vcc, 2, v166
    v_cmp_eq_u32 s[56:57], 3, v166
    s_nop 0
    v_cndmask_b32 v145, 0, v167, vcc
    v_cndmask_b32 v145, v145, v168, s[56:57]
    v_cmp_eq_u32 vcc, 4, v166
    v_cmp_eq_u32 s[56:57], 5, v166
    s_nop 0
    v_cndmask_b32 v146, 0, v167, vcc
    v_cndmask_b32 v146, v146, v168, s[56:57]
    v_cmp_eq_u32 vcc, 6, v166
    v_cmp_eq_u32 s[56:57], 7, v166
    s_nop 0
    v_cndmask_b32 v147, 0, v167, vcc
    v_cndmask_b32 v147, v147, v168, s[56:57]
    v_cmp_eq_u32 vcc, -8, v166
    v_cmp_eq_u32 s[56:57], -7, v166
    s_nop 0
    v_cndmask_b32 v148, 0, v167, vcc
    v_cndmask_b32 v148, v148, v168, s[56:57]
    v_cmp_eq_u32 vcc, -6, v166
    v_cmp_eq_u32 s[56:57], -5, v166
    s_nop 0
    v_cndmask_b32 v149, 0, v167, vcc
    v_cndmask_b32 v149, v149, v168, s[56:57]
    v_cmp_eq_u32 vcc, -4, v166
    v_cmp_eq_u32 s[56:57], -3, v166
    s_nop 0
    v_cndmask_b32 v150, 0, v167, vcc
    v_cndmask_b32 v150, v150, v168, s[56:57]
    v_cmp_eq_u32 vcc, -2, v166
    v_cmp_eq_u32 s[56:57], -1, v166
    s_nop 0
    v_cndmask_b32 v151, 0, v167, vcc
    v_cndmask_b32 v151, v151, v168, s[56:57]
    v_cmp_eq_u32 vcc, -16, v166
    v_cmp_eq_u32 s[56:57], -15, v166
    s_nop 0
    v_cndmask_b32 v152, 0, v167, vcc
    v_cndmask_b32 v152, v152, v168, s[56:57]
    v_cmp_eq_u32 vcc, -14, v166
    v_cmp_eq_u32 s[56:57], -13, v166
    s_nop 0
    v_cndmask_b32 v153, 0, v167, vcc
    v_cndmask_b32 v153, v153, v168, s[56:57]
    v_cmp_eq_u32 vcc, -12, v166
    v_cmp_eq_u32 s[56:57], -11, v166
    s_nop 0
    v_cndmask_b32 v154, 0, v167, vcc
    v_cndmask_b32 v154, v154, v168, s[56:57]
    v_cmp_eq_u32 vcc, -10, v166
    v_cmp_eq_u32 s[56:57], -9, v166
    s_nop 0
    v_cndmask_b32 v155, 0, v167, vcc
    v_cndmask_b32 v155, v155, v168, s[56:57]
    s_nop 1
    s_branch LS_svd
LS_sv5:
    s_cmp_ge_u32 s8, 4
    s_cbranch_scc1 LS_svd
    v_lshlrev_b32 v166, 3, v241
    v_sub_u32 v166, v244, v166
    v_mov_b32 v167, 0x3f80
    v_mov_b32 v168, 0x3f800000
    v_cmp_eq_u32 vcc, 0, v166
    v_cmp_eq_u32 s[56:57], 1, v166
    s_nop 0
    v_cndmask_b32 v128, 0, v167, vcc
    v_cndmask_b32 v128, v128, v168, s[56:57]
    v_cmp_eq_u32 vcc, 2, v166
    v_cmp_eq_u32 s[56:57], 3, v166
    s_nop 0
    v_cndmask_b32 v129, 0, v167, vcc
    v_cndmask_b32 v129, v129, v168, s[56:57]
    v_cmp_eq_u32 vcc, 4, v166
    v_cmp_eq_u32 s[56:57], 5, v166
    s_nop 0
    v_cndmask_b32 v130, 0, v167, vcc
    v_cndmask_b32 v130, v130, v168, s[56:57]
    v_cmp_eq_u32 vcc, 6, v166
    v_cmp_eq_u32 s[56:57], 7, v166
    s_nop 0
    v_cndmask_b32 v131, 0, v167, vcc
    v_cndmask_b32 v131, v131, v168, s[56:57]
    v_cmp_eq_u32 vcc, -4, v166
    v_cmp_eq_u32 s[56:57], -3, v166
    s_nop 0
    v_cndmask_b32 v132, 0, v167, vcc
    v_cndmask_b32 v132, v132, v168, s[56:57]
    v_cmp_eq_u32 vcc, -2, v166
    v_cmp_eq_u32 s[56:57], -1, v166
    s_nop 0
    v_cndmask_b32 v133, 0, v167, vcc
    v_cndmask_b32 v133, v133, v168, s[56:57]
    v_cmp_eq_u32 vcc, 0, v166
    v_cmp_eq_u32 s[56:57], 1, v166
    s_nop 0
    v_cndmask_b32 v134, 0, v167, vcc
    v_cndmask_b32 v134, v134, v168, s[56:57]
    v_cmp_eq_u32 vcc, 2, v166
    v_cmp_eq_u32 s[56:57], 3, v166
    s_nop 0
    v_cndmask_b32 v135, 0, v167, vcc
    v_cndmask_b32 v135, v135, v168, s[56:57]
    v_lshlrev_b32 v166, 3, v241
    v_sub_u32 v166, v240, v166
    v_mov_b32 v167, 0x3f80
    v_mov_b32 v168, 0x3f800000
    v_cmp_eq_u32 vcc, 0, v166
    v_cmp_eq_u32 s[56:57], 1, v166
    s_nop 0
    v_cndmask_b32 v136, 0, v167, vcc
    v_cndmask_b32 v136, v136, v168, s[56:57]
    v_cmp_eq_u32 vcc, 2, v166
    v_cmp_eq_u32 s[56:57], 3, v166
    s_nop 0
    v_cndmask_b32 v137, 0, v167, vcc
    v_cndmask_b32 v137, v137, v168, s[56:57]
    v_cmp_eq_u32 vcc, 4, v166
    v_cmp_eq_u32 s[56:57], 5, v166
    s_nop 0
    v_cndmask_b32 v138, 0, v167, vcc
    v_cndmask_b32 v138, v138, v168, s[56:57]
    v_cmp_eq_u32 vcc, 6, v166
    v_cmp_eq_u32 s[56:57], 7, v166
    s_nop 0
    v_cndmask_b32 v139, 0, v167, vcc
    v_cndmask_b32 v139, v139, v168, s[56:57]
    s_nop 1
LS_svd:
    v_lshrrev_b32 v5, 1, v250
    v_mul_u32_u24 v6, 1249, v5
    v_lshrrev_b32 v6, 17, v6
    v_mul_u32_u24 v7, 105, v6
    v_sub_u32 v7, v5, v7
    v_mul_u32_u24 v22, 205, v7
    v_lshrrev_b32 v22, 10, v22
    v_mul_u32_u24 v23, 5, v22
    v_sub_u32 v23, v7, v23
    v_mul_u32_u24 v16, 5, v6
    v_add_u32 v16, v16, v23
    v_lshlrev_b32 v18, 8, v16
    v_and_b32 v17, 1, v250
    v_lshl_add_u32 v18, v17, 3, v18
    v_add_u32 v18, 103424, v18
    v_mul_u32_u24 v24, 20, v6
    v_add_u32 v24, v24, v22
    v_bfe_u32 v15, v24, 2, 1
    v_mul_u32_u24 v15, 3072, v15
    v_lshrrev_b32 v17, 3, v24
    v_lshl_add_u32 v15, v17, 6, v15
    v_and_b32 v17, 3, v24
    v_lshl_add_u32 v15, v17, 4, v15
    v_subrev_u32 v17, 32, v24
    v_lshrrev_b32 v19, 1, v17
    v_lshlrev_b32 v19, 6, v19
    v_and_b32 v17, 1, v17
    v_lshl_add_u32 v19, v17, 4, v19
    v_add_u32 v19, 6176, v19
    v_cmp_lt_u32 vcc, 31, v24
    s_nop 1
    v_cndmask_b32 v15, v15, v19, vcc
    v_lshlrev_b32 v19, 4, v6
    v_add_u32 v19, 6144, v19
    v_cmp_eq_u32 s[20:21], 20, v22
    s_nop 1
    v_cndmask_b32 v15, v15, v19, s[20:21]
    v_add_u32 v18, v18, v15
    v_lshlrev_b32 v5, 4, v250
    v_mov_b32 v6, 1073741824
    v_mov_b32 v7, 420
    v_cmp_lt_u32 s[22:23], v250, v7
    s_nop 1
    v_cndmask_b32 v5, v6, v5, s[22:23]
    s_lshl_b32 s19, s10, 7
    s_add_u32 s19, s19, 393216
    s_lshl_b32 s18, s11, 2
    s_add_u32 s18, s18, s19
    s_mul_i32 s16, s10, 6720
    s_add_u32 s16, s16, 524288
    s_mul_i32 s15, s25, 102400
    s_add_u32 s15, s15, s9
    s_add_u32 s15, s15, 16252928
    v_mov_b32 v28, 0
    v_mov_b32 v29, 0
    v_mov_b32 v30, 0
    v_mov_b32 v31, 0
    v_lshlrev_b32 v8, 4, v250
    v_add_u32 v8, 103424, v8
    v_add_u32 v9, 111616, v1
    s_waitcnt vmcnt(0) lgkmcnt(0)
    s_barrier
    s_and_b32 s66, s2, 7
    s_lshl_b32 s66, s66, 7
    s_lshr_b32 s67, s2, 3
    s_lshl_b32 s67, s67, 2
    s_add_u32 s66, s66, s67
    s_add_u32 s66, s66, 405504
    s_lshl_b32 s68, s25, 7
    s_add_u32 s68, s68, 405504
    s_cmp_lg_u32 s8, 7
    s_cbranch_scc1 Lsf_1
    v_mov_b32 v2, 1
    v_mov_b32 v3, 0
    s_mov_b64 exec, 1
    buffer_store_dword v2, v3, s[4:7], s18 offen sc1
    s_mov_b64 exec, -1
Lsf_1:
    ds_write_b128 v8, v[28:31]
    ds_write_b128 v9, v[28:31]
    s_cmp_ge_u32 s2, 160
    s_cbranch_scc1 LS_do5
    s_lshl_b32 s63, s54, 2
    s_add_u32 s63, s63, s29
    s_cmp_ge_u32 s63, 31
    s_cbranch_scc1 LS_none
    v_lshlrev_b32 v170, 5, v241
    v_add_u32 v170, 160384, v170
    ds_read_b128 v[172:175], v164 offset:0
    ds_read_b128 v[180:183], v164 offset:16384
    ds_read_b128 v[176:179], v165 offset:0
    ds_read_b128 v[184:187], v165 offset:16384
    ds_read_b128 v[188:191], v170
    ds_read_b128 v[192:195], v170 offset:16
    ds_read_b128 v[196:199], v170 offset:128
    ds_read_b128 v[200:203], v170 offset:144
    v_mov_b32 v220, 0x3f803f80
    v_mov_b32 v221, 0x3f803f80
    v_mov_b32 v222, 0x3f803f80
    v_mov_b32 v223, 0x3f803f80
    v_mov_b32 v96, 0
    v_mov_b32 v97, 0
    v_mov_b32 v98, 0
    v_mov_b32 v99, 0
    v_mov_b32 v100, 0
    v_mov_b32 v101, 0
    v_mov_b32 v102, 0
    v_mov_b32 v103, 0
    s_mul_i32 s17, s63, 143360
    s_mul_i32 s64, s55, 7168
    s_add_u32 s17, s17, s64
    s_lshl_b32 s64, s28, 12
    s_add_u32 s17, s17, s64
    s_add_u32 s17, s17, 19922944
    s_waitcnt lgkmcnt(0)
    v_cvt_pk_bf16_f32 v224, v188, v189
    v_cvt_pk_bf16_f32 v225, v190, v191
    v_cvt_pk_bf16_f32 v226, v192, v193
    v_cvt_pk_bf16_f32 v227, v194, v195
    v_mfma_f32_16x16x32_bf16 v[204:207], v[172:175], v[128:131], 0
    v_mfma_f32_16x16x32_bf16 v[204:207], v[180:183], v[144:147], v[204:207]
    v_mfma_f32_16x16x32_bf16 v[208:211], v[176:179], v[128:131], 0
    v_mfma_f32_16x16x32_bf16 v[208:211], v[184:187], v[144:147], v[208:211]
    s_nop 5
    v_cvt_pk_bf16_f32 v56, v204, v205
    v_cvt_pk_bf16_f32 v57, v206, v207
    v_cvt_pk_bf16_f32 v58, v208, v209
    v_cvt_pk_bf16_f32 v59, v210, v211
    v_pk_mul_f32 v[204:205], v[204:205], v[196:197]
    v_pk_mul_f32 v[206:207], v[206:207], v[198:199]
    v_pk_mul_f32 v[208:209], v[208:209], v[200:201]
    v_pk_mul_f32 v[210:211], v[210:211], v[202:203]
    v_cvt_pk_bf16_f32 v64, v204, v205
    v_cvt_pk_bf16_f32 v65, v206, v207
    v_cvt_pk_bf16_f32 v66, v208, v209
    v_cvt_pk_bf16_f32 v67, v210, v211
    buffer_store_dwordx4 v[64:67], v1, s[4:7], s17 offen offset:0 sc1
    s_nop 0
    v_mfma_f32_16x16x32_bf16 v[72:75], v[220:223], v[64:67], 0
    v_mfma_f32_16x16x32_bf16 v[76:79], v[224:227], v[56:59], 0
    v_mfma_f32_16x16x32_bf16 v[212:215], v[172:175], v[132:135], 0
    v_mfma_f32_16x16x32_bf16 v[212:215], v[180:183], v[148:151], v[212:215]
    v_mfma_f32_16x16x32_bf16 v[216:219], v[176:179], v[132:135], 0
    v_mfma_f32_16x16x32_bf16 v[216:219], v[184:187], v[148:151], v[216:219]
    s_nop 5
    v_cvt_pk_bf16_f32 v60, v212, v213
    v_cvt_pk_bf16_f32 v61, v214, v215
    v_cvt_pk_bf16_f32 v62, v216, v217
    v_cvt_pk_bf16_f32 v63, v218, v219
    v_pk_mul_f32 v[212:213], v[212:213], v[196:197]
    v_pk_mul_f32 v[214:215], v[214:215], v[198:199]
    v_pk_mul_f32 v[216:217], v[216:217], v[200:201]
    v_pk_mul_f32 v[218:219], v[218:219], v[202:203]
    v_cvt_pk_bf16_f32 v68, v212, v213
    v_cvt_pk_bf16_f32 v69, v214, v215
    v_cvt_pk_bf16_f32 v70, v216, v217
    v_cvt_pk_bf16_f32 v71, v218, v219
    buffer_store_dwordx4 v[68:71], v1, s[4:7], s17 offen offset:1024 sc1
    s_nop 0
    v_mfma_f32_16x16x32_bf16 v[80:83], v[220:223], v[68:71], 0
    v_mfma_f32_16x16x32_bf16 v[84:87], v[224:227], v[60:63], 0
    v_mfma_f32_16x16x32_bf16 v[204:207], v[172:175], v[136:139], 0
    v_mfma_f32_16x16x32_bf16 v[204:207], v[180:183], v[152:155], v[204:207]
    v_mfma_f32_16x16x32_bf16 v[208:211], v[176:179], v[136:139], 0
    v_mfma_f32_16x16x32_bf16 v[208:211], v[184:187], v[152:155], v[208:211]
    s_nop 5
    v_cvt_pk_bf16_f32 v56, v204, v205
    v_cvt_pk_bf16_f32 v57, v206, v207
    v_cvt_pk_bf16_f32 v58, v208, v209
    v_cvt_pk_bf16_f32 v59, v210, v211
    v_pk_mul_f32 v[204:205], v[204:205], v[196:197]
    v_pk_mul_f32 v[206:207], v[206:207], v[198:199]
    v_pk_mul_f32 v[208:209], v[208:209], v[200:201]
    v_pk_mul_f32 v[210:211], v[210:211], v[202:203]
    v_cvt_pk_bf16_f32 v64, v204, v205
    v_cvt_pk_bf16_f32 v65, v206, v207
    v_cvt_pk_bf16_f32 v66, v208, v209
    v_cvt_pk_bf16_f32 v67, v210, v211
    buffer_store_dwordx4 v[64:67], v1, s[4:7], s17 offen offset:2048 sc1
    s_nop 0
    v_mfma_f32_16x16x32_bf16 v[88:91], v[220:223], v[64:67], 0
    v_mfma_f32_16x16x32_bf16 v[92:95], v[224:227], v[56:59], 0
    s_cmp_eq_u32 s28, 1
    s_nop 6
    s_cbranch_scc1 LS_wgu3
    v_mfma_f32_16x16x32_bf16 v[212:215], v[172:175], v[140:143], 0
    v_mfma_f32_16x16x32_bf16 v[212:215], v[180:183], v[156:159], v[212:215]
    v_mfma_f32_16x16x32_bf16 v[216:219], v[176:179], v[140:143], 0
    v_mfma_f32_16x16x32_bf16 v[216:219], v[184:187], v[156:159], v[216:219]
    s_nop 5
    v_cvt_pk_bf16_f32 v60, v212, v213
    v_cvt_pk_bf16_f32 v61, v214, v215
    v_cvt_pk_bf16_f32 v62, v216, v217
    v_cvt_pk_bf16_f32 v63, v218, v219
    v_pk_mul_f32 v[212:213], v[212:213], v[196:197]
    v_pk_mul_f32 v[214:215], v[214:215], v[198:199]
    v_pk_mul_f32 v[216:217], v[216:217], v[200:201]
    v_pk_mul_f32 v[218:219], v[218:219], v[202:203]
    v_cvt_pk_bf16_f32 v68, v212, v213
    v_cvt_pk_bf16_f32 v69, v214, v215
    v_cvt_pk_bf16_f32 v70, v216, v217
    v_cvt_pk_bf16_f32 v71, v218, v219
    buffer_store_dwordx4 v[68:71], v1, s[4:7], s17 offen offset:3072 sc1
    s_nop 0
    v_mfma_f32_16x16x32_bf16 v[96:99], v[220:223], v[68:71], 0
    v_mfma_f32_16x16x32_bf16 v[100:103], v[224:227], v[60:63], 0
    s_nop 7
LS_wgu3:
    v_mov_b32 v44, v72
    v_cmp_eq_u32 vcc, 1, v241
    s_nop 1
    v_cndmask_b32 v44, v44, v80, vcc
    v_cmp_eq_u32 vcc, 2, v241
    s_nop 1
    v_cndmask_b32 v44, v44, v88, vcc
    v_cmp_eq_u32 vcc, 3, v241
    s_nop 1
    v_cndmask_b32 v44, v44, v96, vcc
    v_mov_b32 v45, v76
    v_cmp_eq_u32 vcc, 1, v241
    s_nop 1
    v_cndmask_b32 v45, v45, v84, vcc
    v_cmp_eq_u32 vcc, 2, v241
    s_nop 1
    v_cndmask_b32 v45, v45, v92, vcc
    v_cmp_eq_u32 vcc, 3, v241
    s_nop 1
    v_cndmask_b32 v45, v45, v100, vcc
    s_mul_i32 s17, s63, 20
    s_add_u32 s17, s17, s55
    s_lshl_b32 s17, s17, 10
    s_lshl_b32 s64, s28, 8
    s_add_u32 s17, s17, s64
    s_add_u32 s17, s17, 35651584
    v_lshlrev_b32 v46, 2, v0
    buffer_store_dword v44, v46, s[4:7], s17 offen sc1
    buffer_store_dword v45, v46, s[4:7], s17 offen offset:512 sc1
    s_branch LS_done
LS_do5:
    s_cmp_ge_u32 s8, 4
    s_cbranch_scc1 LS_none
    ds_read_b128 v[172:175], v160
    ds_read_b128 v[184:187], v161
    ds_read_b128 v[176:179], v162
    ds_read_b128 v[188:191], v163
    ds_read_b128 v[180:183], v164
    ds_read_b128 v[192:195], v165
    s_cmp_ge_u32 s55, 27
    s_cselect_b32 s64, 1, 0
    s_mul_i32 s17, s64, 27
    s_sub_u32 s17, s55, s17
    s_lshl_b32 s17, s17, 1
    s_add_u32 s17, s17, s64
    s_mul_i32 s17, s17, 5120
    s_lshl_b32 s64, s54, 2
    s_add_u32 s64, s64, s8
    s_mul_i32 s64, s64, 276480
    s_add_u32 s17, s17, s64
    s_add_u32 s17, s17, 31981568
    s_waitcnt lgkmcnt(0)
    v_mfma_f32_16x16x32_bf16 v[204:207], v[172:175], v[128:131], 0
    v_mfma_f32_16x16x32_bf16 v[208:211], v[184:187], v[128:131], 0
    s_nop 6
    v_cvt_pk_bf16_f32 v64, v204, v205
    v_cvt_pk_bf16_f32 v65, v206, v207
    v_cvt_pk_bf16_f32 v66, v208, v209
    v_cvt_pk_bf16_f32 v67, v210, v211
    buffer_store_dwordx4 v[64:67], v1, s[4:7], s17 offen offset:0 sc1
    v_mfma_f32_16x16x32_bf16 v[212:215], v[172:175], v[132:135], 0
    v_mfma_f32_16x16x32_bf16 v[216:219], v[184:187], v[132:135], 0
    s_nop 6
    v_cvt_pk_bf16_f32 v68, v212, v213
    v_cvt_pk_bf16_f32 v69, v214, v215
    v_cvt_pk_bf16_f32 v70, v216, v217
    v_cvt_pk_bf16_f32 v71, v218, v219
    buffer_store_dwordx4 v[68:71], v1, s[4:7], s17 offen offset:1024 sc1
    v_mfma_f32_16x16x32_bf16 v[204:207], v[176:179], v[128:131], 0
    v_mfma_f32_16x16x32_bf16 v[208:211], v[188:191], v[128:131], 0
    s_nop 6
    v_cvt_pk_bf16_f32 v64, v204, v205
    v_cvt_pk_bf16_f32 v65, v206, v207
    v_cvt_pk_bf16_f32 v66, v208, v209
    v_cvt_pk_bf16_f32 v67, v210, v211
    buffer_store_dwordx4 v[64:67], v1, s[4:7], s17 offen offset:2048 sc1
    v_mfma_f32_16x16x32_bf16 v[212:215], v[176:179], v[132:135], 0
    v_mfma_f32_16x16x32_bf16 v[216:219], v[188:191], v[132:135], 0
    s_nop 6
    v_cvt_pk_bf16_f32 v68, v212, v213
    v_cvt_pk_bf16_f32 v69, v214, v215
    v_cvt_pk_bf16_f32 v70, v216, v217
    v_cvt_pk_bf16_f32 v71, v218, v219
    buffer_store_dwordx4 v[68:71], v1, s[4:7], s17 offen offset:3072 sc1
    v_mfma_f32_16x16x32_bf16 v[204:207], v[180:183], v[136:139], 0
    v_mfma_f32_16x16x32_bf16 v[208:211], v[192:195], v[136:139], 0
    s_nop 6
    v_cvt_pk_bf16_f32 v64, v204, v205
    v_cvt_pk_bf16_f32 v65, v206, v207
    v_cvt_pk_bf16_f32 v66, v208, v209
    v_cvt_pk_bf16_f32 v67, v210, v211
    s_add_u32 s17, s17, 4096
    buffer_store_dwordx4 v[64:67], v1, s[4:7], s17 offen offset:0 sc1
    s_nop 1
LS_none:
LS_done:
    s_cmp_lg_u32 s8, 7
    s_cbranch_scc1 Lpw_2
    v_lshlrev_b32 v3, 2, v0
    s_mov_b32 exec_lo, 0xffff
    s_mov_b32 exec_hi, 0x0
    s_mov_b32 s58, 0
Lpl_3:
    buffer_load_dword v2, v3, s[4:7], s19 offen sc1
    s_add_u32 s58, s58, 1
    s_waitcnt vmcnt(0)
    v_cmp_eq_u32 vcc, 1, v2
    s_cmp_gt_u32 s58, 400000
    s_nop 3
    s_cbranch_scc1 Lpe_4
    s_cmp_eq_u64 vcc, exec
    s_cbranch_scc0 Lpl_3
Lpe_4:
    s_mov_b64 exec, -1
Lpw_2:
    s_waitcnt lgkmcnt(0)
    s_barrier
    buffer_load_dwordx4 v[64:67], v5, s[4:7], s16 offen sc1
    s_add_u32 s16, s16, 107520
    buffer_load_dwordx4 v[68:71], v5, s[4:7], s16 offen sc1
    s_add_u32 s16, s16, 107520
    buffer_load_dwordx4 v[72:75], v5, s[4:7], s16 offen sc1
    s_add_u32 s16, s16, 107520
    buffer_load_dwordx4 v[76:79], v5, s[4:7], s16 offen sc1
    s_add_u32 s16, s16, 107520
    buffer_load_dwordx4 v[80:83], v5, s[4:7], s16 offen sc1
    s_add_u32 s16, s16, 107520
    buffer_load_dwordx4 v[84:87], v5, s[4:7], s16 offen sc1
    s_add_u32 s16, s16, 107520
    buffer_load_dwordx4 v[88:91], v5, s[4:7], s16 offen sc1
    s_add_u32 s16, s16, 107520
    buffer_load_dwordx4 v[92:95], v5, s[4:7], s16 offen sc1
    s_add_u32 s16, s16, 107520
    buffer_load_dwordx4 v[96:99], v5, s[4:7], s16 offen sc1
    s_add_u32 s16, s16, 107520
    buffer_load_dwordx4 v[100:103], v5, s[4:7], s16 offen sc1
    s_add_u32 s16, s16, 107520
    buffer_load_dwordx4 v[104:107], v5, s[4:7], s16 offen sc1
    s_add_u32 s16, s16, 107520
    buffer_load_dwordx4 v[108:111], v5, s[4:7], s16 offen sc1
    s_add_u32 s16, s16, 107520
    buffer_load_dwordx4 v[112:115], v5, s[4:7], s16 offen sc1
    s_add_u32 s16, s16, 107520
    buffer_load_dwordx4 v[116:119], v5, s[4:7], s16 offen sc1
    s_add_u32 s16, s16, 107520
    buffer_load_dwordx4 v[120:123], v5, s[4:7], s16 offen sc1
    s_add_u32 s16, s16, 107520
    buffer_load_dwordx4 v[124:127], v5, s[4:7], s16 offen sc1
    s_mul_i32 s17, s8, 2560
    s_add_u32 s17, s17, 138240
    v_add_u32 v8, s17, v1
    v_mov_b32 v40, 0
    v_mov_b32 v41, 0
    v_mov_b32 v42, 0
    v_mov_b32 v43, 0
    ds_read_b128 v[32:35], v8
    ds_read_b128 v[36:39], v8 offset:1024
    s_mov_b32 exec_hi, 0
    ds_read_b128 v[40:43], v8 offset:2048
    s_mov_b32 exec_hi, -1
    s_lshl_b32 s17, s11, 3
    s_add_u32 s17, s17, s8
    s_mul_i32 s17, s17, 20480
    s_mul_i32 s18, s10, 1280
    s_add_u32 s17, s17, s18
    s_add_u32 s17, s17, 13631488
    v_cmp_gt_u32 s[64:65], 3, v241
    v_cmp_gt_u32 s[66:67], 2, v241
    s_mov_b32 s63, 0x358637bd
    v_add_u32 v10, 103424, v1
    s_waitcnt vmcnt(13)
    v_pk_add_f32 v[64:65], v[64:65], v[72:73]
    v_pk_add_f32 v[66:67], v[66:67], v[74:75]
    s_waitcnt vmcnt(12)
    v_pk_add_f32 v[68:69], v[68:69], v[76:77]
    v_pk_add_f32 v[70:71], v[70:71], v[78:79]
    s_waitcnt vmcnt(11)
    v_pk_add_f32 v[64:65], v[64:65], v[80:81]
    v_pk_add_f32 v[66:67], v[66:67], v[82:83]
    s_waitcnt vmcnt(10)
    v_pk_add_f32 v[68:69], v[68:69], v[84:85]
    v_pk_add_f32 v[70:71], v[70:71], v[86:87]
    s_waitcnt vmcnt(9)
    v_pk_add_f32 v[64:65], v[64:65], v[88:89]
    v_pk_add_f32 v[66:67], v[66:67], v[90:91]
    s_waitcnt vmcnt(8)
    v_pk_add_f32 v[68:69], v[68:69], v[92:93]
    v_pk_add_f32 v[70:71], v[70:71], v[94:95]
    s_waitcnt vmcnt(7)
    v_pk_add_f32 v[64:65], v[64:65], v[96:97]
    v_pk_add_f32 v[66:67], v[66:67], v[98:99]
    s_waitcnt vmcnt(6)
    v_pk_add_f32 v[68:69], v[68:69], v[100:101]
    v_pk_add_f32 v[70:71], v[70:71], v[102:103]
    s_waitcnt vmcnt(5)
    v_pk_add_f32 v[64:65], v[64:65], v[104:105]
    v_pk_add_f32 v[66:67], v[66:67], v[106:107]
    s_waitcnt vmcnt(4)
    v_pk_add_f32 v[68:69], v[68:69], v[108:109]
    v_pk_add_f32 v[70:71], v[70:71], v[110:111]
    s_waitcnt vmcnt(3)
    v_pk_add_f32 v[64:65], v[64:65], v[112:113]
    v_pk_add_f32 v[66:67], v[66:67], v[114:115]
    s_waitcnt vmcnt(2)
    v_pk_add_f32 v[68:69], v[68:69], v[116:117]
    v_pk_add_f32 v[70:71], v[70:71], v[118:119]
    s_waitcnt vmcnt(1)
    v_pk_add_f32 v[64:65], v[64:65], v[120:121]
    v_pk_add_f32 v[66:67], v[66:67], v[122:123]
    s_waitcnt vmcnt(0)
    v_pk_add_f32 v[68:69], v[68:69], v[124:125]
    v_pk_add_f32 v[70:71], v[70:71], v[126:127]
    v_pk_add_f32 v[64:65], v[64:65], v[68:69]
    v_pk_add_f32 v[66:67], v[66:67], v[70:71]
    v_cvt_pk_bf16_f32 v12, v64, v65
    v_cvt_pk_bf16_f32 v13, v66, v67
    s_mov_b64 exec, s[22:23]
    ds_write_b64 v18, v[12:13]
    s_and_b64 exec, exec, s[20:21]
    ds_write_b64 v18, v[12:13] offset:64
    ds_write_b64 v18, v[12:13] offset:128
    ds_write_b64 v18, v[12:13] offset:192
    s_mov_b64 exec, -1
    s_waitcnt lgkmcnt(0)
    s_barrier
    ds_read_b128 v[64:67], v10 offset:0
    ds_read_b128 v[68:71], v10 offset:1024
    ds_read_b128 v[72:75], v10 offset:2048
    ds_read_b128 v[76:79], v10 offset:3072
    ds_read_b128 v[80:83], v10 offset:4096
    ds_read_b128 v[84:87], v10 offset:5120
    ds_read_b128 v[88:91], v10 offset:6144
    ds_read_b128 v[92:95], v10 offset:7168
    ds_read_b128 v[96:99], v10 offset:8192
    s_waitcnt lgkmcnt(0)
    v_mfma_f32_16x16x32_bf16 v[108:111], v[88:91], v[32:35], 0
    v_mfma_f32_16x16x32_bf16 v[100:103], v[64:67], v[32:35], 0
    v_mfma_f32_16x16x32_bf16 v[104:107], v[76:79], v[32:35], 0
    v_mfma_f32_16x16x32_bf16 v[108:111], v[92:95], v[36:39], v[108:111]
    v_mfma_f32_16x16x32_bf16 v[100:103], v[68:71], v[36:39], v[100:103]
    v_mfma_f32_16x16x32_bf16 v[104:107], v[80:83], v[36:39], v[104:107]
    v_mfma_f32_16x16x32_bf16 v[108:111], v[96:99], v[40:43], v[108:111]
    v_mfma_f32_16x16x32_bf16 v[100:103], v[72:75], v[40:43], v[100:103]
    v_mfma_f32_16x16x32_bf16 v[104:107], v[84:87], v[40:43], v[104:107]
    s_nop 5
    v_add_f32 v108, s63, v108
    v_add_f32 v109, s63, v109
    v_rcp_f32 v108, v108
    v_rcp_f32 v109, v109
    s_nop 0
    v_cndmask_b32 v12, v109, v108, s[64:65]
    v_cndmask_b32 v13, v109, v108, s[66:67]
    v_mul_f32 v100, v100, v12
    v_mul_f32 v101, v101, v12
    v_mul_f32 v102, v102, v12
    v_mul_f32 v103, v103, v12
    v_mul_f32 v104, v104, v13
    v_mul_f32 v105, v105, v13
    v_mul_f32 v106, v106, v13
    v_mul_f32 v107, v107, v13
    v_mul_f32 v110, v110, v109
    v_mul_f32 v111, v111, v109
    v_cvt_pk_bf16_f32 v48, v100, v101
    v_cvt_pk_bf16_f32 v49, v102, v103
    v_cvt_pk_bf16_f32 v50, v104, v105
    v_cvt_pk_bf16_f32 v51, v106, v107
    v_cvt_pk_bf16_f32 v52, v110, v111
    buffer_store_dwordx4 v[48:51], v1, s[4:7], s17 offen sc1
    buffer_store_dword v52, v249, s[4:7], s17 offen offset:1024 sc1
    s_mul_i32 s65, s25, 20
    s_add_u32 s65, s65, 320
    v_add_u32 v20, s65, v0
    v_add_u32 v21, 460, v20
    v_cmp_lt_u32 vcc, 19, v0
    s_nop 1
    v_cndmask_b32 v20, v20, v21, vcc
    v_lshlrev_b32 v20, 4, v20
    v_add_u32 v23, 159744, v1
    s_cmp_lt_u32 s2, 160
    s_cselect_b32 s64, 0, 4096
    s_lshl_b32 s65, s54, 8
    s_add_u32 s64, s64, s65
    s_lshl_b32 s65, s55, 2
    s_add_u32 s64, s64, s65
    s_add_u32 s64, s64, 399360
    s_lshl_b32 s17, s11, 7
    s_lshl_b32 s18, s10, 2
    s_add_u32 s17, s17, s18
    s_add_u32 s17, s17, 395264
    s_lshr_b32 s19, s24, 1
    s_lshl_b32 s19, s19, 7
    s_add_u32 s19, s19, 395264
    s_mul_i32 s12, s52, 10240
    s_add_u32 s12, s12, s31
    s_add_u32 s12, s12, 13631488
    s_lshr_b32 s66, s25, 2
    s_lshl_b32 s66, s66, 8
    s_add_u32 s66, s66, 403456
    s_lshr_b32 s67, s27, 2
    s_lshl_b32 s67, s67, 8
    s_add_u32 s67, s67, 399360
    s_waitcnt vmcnt(0)
    s_barrier
    s_cmp_lg_u32 s8, 7
    s_cbranch_scc1 Lsf_5
    v_mov_b32 v2, 1
    v_mov_b32 v3, 0
    s_mov_b64 exec, 1
    buffer_store_dword v2, v3, s[4:7], s17 offen sc1
    buffer_store_dword v2, v3, s[4:7], s64 offen sc1
    s_mov_b64 exec, -1
Lsf_5:
    s_cmp_lg_u32 s8, 6
    s_cbranch_scc1 LS_notab
    s_mov_b32 s17, 0
    buffer_load_dwordx4 v[28:31], v20, s[4:7], s17 offen sc1
    s_mov_b32 s17, 15360
    buffer_load_dwordx4 v[32:35], v20, s[4:7], s17 offen sc1
    s_mov_b32 s17, 30720
    buffer_load_dwordx4 v[36:39], v20, s[4:7], s17 offen sc1
    s_mov_b32 s17, 46080
    buffer_load_dwordx4 v[40:43], v20, s[4:7], s17 offen sc1
LS_notab:
    s_cmp_eq_u32 s8, 7
    s_cbranch_scc1 Ld7_6
    s_add_u32 m0, s9, 0
    s_nop 0
    buffer_load_dwordx4 v1, s[4:7], s15 offen sc1 lds
    s_add_u32 s15, s15, 7168
    s_add_u32 m0, s9, 7168
    s_nop 0
    buffer_load_dwordx4 v1, s[4:7], s15 offen sc1 lds
    s_add_u32 s15, s15, 7168
    s_add_u32 m0, s9, 14336
    s_nop 0
    buffer_load_dwordx4 v1, s[4:7], s15 offen sc1 lds
    s_add_u32 s15, s15, 7168
    s_add_u32 m0, s9, 21504
    s_nop 0
    buffer_load_dwordx4 v1, s[4:7], s15 offen sc1 lds
    s_add_u32 s15, s15, 7168
    s_add_u32 m0, s9, 28672
    s_nop 0
    buffer_load_dwordx4 v1, s[4:7], s15 offen sc1 lds
    s_add_u32 s15, s15, 7168
    s_add_u32 m0, s9, 35840
    s_nop 0
    buffer_load_dwordx4 v1, s[4:7], s15 offen sc1 lds
    s_add_u32 s15, s15, 7168
    s_add_u32 m0, s9, 43008
    s_nop 0
    buffer_load_dwordx4 v1, s[4:7], s15 offen sc1 lds
    s_add_u32 s15, s15, 7168
    s_add_u32 m0, s9, 50176
    s_nop 0
    buffer_load_dwordx4 v1, s[4:7], s15 offen sc1 lds
    s_add_u32 s15, s15, 7168
    s_add_u32 m0, s9, 57344
    s_nop 0
    buffer_load_dwordx4 v1, s[4:7], s15 offen sc1 lds
    s_add_u32 s15, s15, 7168
    s_add_u32 m0, s9, 64512
    s_nop 0
    buffer_load_dwordx4 v1, s[4:7], s15 offen sc1 lds
    s_add_u32 s15, s15, 7168
    s_add_u32 m0, s9, 71680
    s_nop 0
    buffer_load_dwordx4 v1, s[4:7], s15 offen sc1 lds
    s_add_u32 s15, s15, 7168
    s_add_u32 m0, s9, 78848
    s_nop 0
    buffer_load_dwordx4 v1, s[4:7], s15 offen sc1 lds
    s_add_u32 s15, s15, 7168
    s_add_u32 m0, s9, 86016
    s_nop 0
    buffer_load_dwordx4 v1, s[4:7], s15 offen sc1 lds
    s_add_u32 s15, s15, 7168
    s_add_u32 m0, s9, 93184
    s_nop 0
    buffer_load_dwordx4 v1, s[4:7], s15 offen sc1 lds
    s_add_u32 s15, s15, 7168
    s_cmp_ge_u32 s8, 2
    s_cbranch_scc1 Ld7_6
    s_add_u32 m0, s9, 100352
    s_nop 0
    buffer_load_dwordx4 v1, s[4:7], s15 offen sc1 lds
    s_add_u32 s15, s15, 7168
Ld7_6:
    s_cmp_lg_u32 s8, 6
    s_cbranch_scc1 LS_notab2
    s_waitcnt vmcnt(14)
    v_add_f32 v28, v28, v32
    v_add_f32 v29, v29, v33
    v_add_f32 v30, v30, v34
    v_add_f32 v31, v31, v35
    v_add_f32 v36, v36, v40
    v_add_f32 v37, v37, v41
    v_add_f32 v38, v38, v42
    v_add_f32 v39, v39, v43
    v_add_f32 v28, v28, v36
    v_add_f32 v29, v29, v37
    v_add_f32 v30, v30, v38
    v_add_f32 v31, v31, v39
    v_cvt_pk_bf16_f32 v32, v28, v29
    v_cvt_pk_bf16_f32 v33, v30, v31
    v_lshlrev_b32 v28, 16, v32
    v_and_b32 v29, 0xffff0000, v32
    v_lshlrev_b32 v30, 16, v33
    v_and_b32 v31, 0xffff0000, v33
    s_mov_b32 exec_hi, 0xff
    ds_write_b128 v23, v[28:31]
    s_mov_b64 exec, -1
LS_notab2:
    s_cmp_eq_u32 s52, 1
    s_cbranch_scc1 LS_nox
    buffer_load_dwordx4 v[8:11], v246, s[32:35], s59 offen
    buffer_load_dwordx4 v[12:15], v246, s[32:35], s59 offen offset:64
    buffer_load_dwordx2 v[16:17], v247, s[32:35], s59 offen offset:128
LS_nox:
    s_cmp_lg_u32 s8, 7
    s_cbranch_scc1 Lpw_7
    v_lshlrev_b32 v3, 2, v0
    s_mov_b32 exec_lo, 0xffff
    s_mov_b32 exec_hi, 0x0
    s_mov_b32 s58, 0
Lpl_8:
    buffer_load_dword v2, v3, s[4:7], s19 offen sc1
    s_add_u32 s58, s58, 1
    s_waitcnt vmcnt(0)
    v_cmp_eq_u32 vcc, 1, v2
    s_cmp_gt_u32 s58, 400000
    s_nop 3
    s_cbranch_scc1 Lpe_9
    s_cmp_eq_u64 vcc, exec
    s_cbranch_scc0 Lpl_8
Lpe_9:
    s_mov_b64 exec, -1
Lpw_7:
    s_barrier
    buffer_load_dwordx4 v[48:51], v1, s[4:7], s12 offen offset:0 sc1
    buffer_load_dwordx4 v[52:55], v1, s[4:7], s12 offen offset:1024 sc1
    buffer_load_dwordx4 v[56:59], v1, s[4:7], s12 offen offset:2048 sc1
    buffer_load_dwordx4 v[60:63], v1, s[4:7], s12 offen offset:3072 sc1
    s_add_u32 s12, s12, 4096
    buffer_load_dwordx4 v[64:67], v1, s[4:7], s12 offen offset:0 sc1
    buffer_load_dwordx4 v[68:71], v1, s[4:7], s12 offen offset:1024 sc1
    buffer_load_dwordx4 v[72:75], v1, s[4:7], s12 offen offset:2048 sc1
    buffer_load_dwordx4 v[76:79], v1, s[4:7], s12 offen offset:3072 sc1
    s_add_u32 s12, s12, 4096
    buffer_load_dwordx4 v[80:83], v1, s[4:7], s12 offen offset:0 sc1
    buffer_load_dwordx4 v[84:87], v1, s[4:7], s12 offen offset:1024 sc1
    s_waitcnt vmcnt(9) lgkmcnt(0)
    s_barrier
    ds_read_b128 v[88:91], v251 offset:0
    ds_read_b128 v[92:95], v251 offset:1024
    ds_read_b128 v[96:99], v251 offset:2048
    ds_read_b128 v[100:103], v251 offset:3072
    ds_read_b128 v[104:107], v251 offset:4096
    s_waitcnt vmcnt(8)
    ds_read_b128 v[108:111], v251 offset:10240
    ds_read_b128 v[112:115], v251 offset:11264
    ds_read_b128 v[116:119], v251 offset:12288
    ds_read_b128 v[120:123], v251 offset:13312
    ds_read_b128 v[124:127], v251 offset:14336
    s_waitcnt vmcnt(7)
    s_waitcnt lgkmcnt(9)
    v_mfma_f32_16x16x32_bf16 v[148:151], v[88:91], v[48:51], 0
    ds_read_b128 v[128:131], v251 offset:20480
    s_waitcnt lgkmcnt(9)
    v_mfma_f32_16x16x32_bf16 v[152:155], v[92:95], v[48:51], 0
    ds_read_b128 v[132:135], v251 offset:21504
    s_waitcnt lgkmcnt(9)
    v_mfma_f32_16x16x32_bf16 v[156:159], v[96:99], v[48:51], 0
    ds_read_b128 v[136:139], v251 offset:22528
    s_waitcnt lgkmcnt(9)
    v_mfma_f32_16x16x32_bf16 v[160:163], v[100:103], v[48:51], 0
    ds_read_b128 v[140:143], v251 offset:23552
    s_waitcnt lgkmcnt(9)
    v_mfma_f32_16x16x32_bf16 v[164:167], v[104:107], v[48:51], 0
    ds_read_b128 v[144:147], v251 offset:24576
    s_waitcnt vmcnt(6)
    s_waitcnt lgkmcnt(9)
    v_mfma_f32_16x16x32_bf16 v[148:151], v[108:111], v[52:55], v[148:151]
    ds_read_b128 v[88:91], v251 offset:30720
    s_waitcnt lgkmcnt(9)
    v_mfma_f32_16x16x32_bf16 v[152:155], v[112:115], v[52:55], v[152:155]
    ds_read_b128 v[92:95], v251 offset:31744
    s_waitcnt lgkmcnt(9)
    v_mfma_f32_16x16x32_bf16 v[156:159], v[116:119], v[52:55], v[156:159]
    ds_read_b128 v[96:99], v251 offset:32768
    s_waitcnt lgkmcnt(9)
    v_mfma_f32_16x16x32_bf16 v[160:163], v[120:123], v[52:55], v[160:163]
    ds_read_b128 v[100:103], v251 offset:33792
    s_waitcnt lgkmcnt(9)
    v_mfma_f32_16x16x32_bf16 v[164:167], v[124:127], v[52:55], v[164:167]
    ds_read_b128 v[104:107], v251 offset:34816
    s_waitcnt vmcnt(5)
    s_waitcnt lgkmcnt(9)
    v_mfma_f32_16x16x32_bf16 v[148:151], v[128:131], v[56:59], v[148:151]
    ds_read_b128 v[108:111], v251 offset:40960
    s_waitcnt lgkmcnt(9)
    v_mfma_f32_16x16x32_bf16 v[152:155], v[132:135], v[56:59], v[152:155]
    ds_read_b128 v[112:115], v251 offset:41984
    s_waitcnt lgkmcnt(9)
    v_mfma_f32_16x16x32_bf16 v[156:159], v[136:139], v[56:59], v[156:159]
    ds_read_b128 v[116:119], v251 offset:43008
    s_waitcnt lgkmcnt(9)
    v_mfma_f32_16x16x32_bf16 v[160:163], v[140:143], v[56:59], v[160:163]
    ds_read_b128 v[120:123], v251 offset:44032
    s_waitcnt lgkmcnt(9)
    v_mfma_f32_16x16x32_bf16 v[164:167], v[144:147], v[56:59], v[164:167]
    ds_read_b128 v[124:127], v251 offset:45056
    s_waitcnt vmcnt(4)
    s_waitcnt lgkmcnt(9)
    v_mfma_f32_16x16x32_bf16 v[148:151], v[88:91], v[60:63], v[148:151]
    ds_read_b128 v[128:131], v251 offset:51200
    s_waitcnt lgkmcnt(9)
    v_mfma_f32_16x16x32_bf16 v[152:155], v[92:95], v[60:63], v[152:155]
    ds_read_b128 v[132:135], v251 offset:52224
    s_waitcnt lgkmcnt(9)
    v_mfma_f32_16x16x32_bf16 v[156:159], v[96:99], v[60:63], v[156:159]
    ds_read_b128 v[136:139], v251 offset:53248
    s_waitcnt lgkmcnt(9)
    v_mfma_f32_16x16x32_bf16 v[160:163], v[100:103], v[60:63], v[160:163]
    ds_read_b128 v[140:143], v251 offset:54272
    s_waitcnt lgkmcnt(9)
    v_mfma_f32_16x16x32_bf16 v[164:167], v[104:107], v[60:63], v[164:167]
    ds_read_b128 v[144:147], v251 offset:55296
    s_waitcnt vmcnt(3)
    s_waitcnt lgkmcnt(9)
    v_mfma_f32_16x16x32_bf16 v[148:151], v[108:111], v[64:67], v[148:151]
    ds_read_b128 v[88:91], v251 offset:61440
    s_waitcnt lgkmcnt(9)
    v_mfma_f32_16x16x32_bf16 v[152:155], v[112:115], v[64:67], v[152:155]
    ds_read_b128 v[92:95], v251 offset:62464
    s_waitcnt lgkmcnt(9)
    v_mfma_f32_16x16x32_bf16 v[156:159], v[116:119], v[64:67], v[156:159]
    ds_read_b128 v[96:99], v251 offset:63488
    s_waitcnt lgkmcnt(9)
    v_mfma_f32_16x16x32_bf16 v[160:163], v[120:123], v[64:67], v[160:163]
    ds_read_b128 v[100:103], v251 offset:64512
    s_waitcnt lgkmcnt(9)
    v_mfma_f32_16x16x32_bf16 v[164:167], v[124:127], v[64:67], v[164:167]
    ds_read_b128 v[104:107], v252 offset:0
    s_waitcnt vmcnt(2)
    s_waitcnt lgkmcnt(9)
    v_mfma_f32_16x16x32_bf16 v[148:151], v[128:131], v[68:71], v[148:151]
    ds_read_b128 v[108:111], v252 offset:6144
    s_waitcnt lgkmcnt(9)
    v_mfma_f32_16x16x32_bf16 v[152:155], v[132:135], v[68:71], v[152:155]
    ds_read_b128 v[112:115], v252 offset:7168
    s_waitcnt lgkmcnt(9)
    v_mfma_f32_16x16x32_bf16 v[156:159], v[136:139], v[68:71], v[156:159]
    ds_read_b128 v[116:119], v252 offset:8192
    s_waitcnt lgkmcnt(9)
    v_mfma_f32_16x16x32_bf16 v[160:163], v[140:143], v[68:71], v[160:163]
    ds_read_b128 v[120:123], v252 offset:9216
    s_waitcnt lgkmcnt(9)
    v_mfma_f32_16x16x32_bf16 v[164:167], v[144:147], v[68:71], v[164:167]
    ds_read_b128 v[124:127], v252 offset:10240
    s_waitcnt vmcnt(1)
    s_waitcnt lgkmcnt(9)
    v_mfma_f32_16x16x32_bf16 v[148:151], v[88:91], v[72:75], v[148:151]
    ds_read_b128 v[128:131], v252 offset:16384
    s_waitcnt lgkmcnt(9)
    v_mfma_f32_16x16x32_bf16 v[152:155], v[92:95], v[72:75], v[152:155]
    ds_read_b128 v[132:135], v252 offset:17408
    s_waitcnt lgkmcnt(9)
    v_mfma_f32_16x16x32_bf16 v[156:159], v[96:99], v[72:75], v[156:159]
    ds_read_b128 v[136:139], v252 offset:18432
    s_waitcnt lgkmcnt(9)
    v_mfma_f32_16x16x32_bf16 v[160:163], v[100:103], v[72:75], v[160:163]
    ds_read_b128 v[140:143], v252 offset:19456
    s_waitcnt lgkmcnt(9)
    v_mfma_f32_16x16x32_bf16 v[164:167], v[104:107], v[72:75], v[164:167]
    ds_read_b128 v[144:147], v252 offset:20480
    s_waitcnt vmcnt(0)
    s_waitcnt lgkmcnt(9)
    v_mfma_f32_16x16x32_bf16 v[148:151], v[108:111], v[76:79], v[148:151]
    ds_read_b128 v[88:91], v252 offset:26624
    s_waitcnt lgkmcnt(9)
    v_mfma_f32_16x16x32_bf16 v[152:155], v[112:115], v[76:79], v[152:155]
    ds_read_b128 v[92:95], v252 offset:27648
    s_waitcnt lgkmcnt(9)
    v_mfma_f32_16x16x32_bf16 v[156:159], v[116:119], v[76:79], v[156:159]
    ds_read_b128 v[96:99], v252 offset:28672
    s_waitcnt lgkmcnt(9)
    v_mfma_f32_16x16x32_bf16 v[160:163], v[120:123], v[76:79], v[160:163]
    ds_read_b128 v[100:103], v252 offset:29696
    s_waitcnt lgkmcnt(9)
    v_mfma_f32_16x16x32_bf16 v[164:167], v[124:127], v[76:79], v[164:167]
    ds_read_b128 v[104:107], v252 offset:30720
    s_waitcnt lgkmcnt(9)
    v_mfma_f32_16x16x32_bf16 v[148:151], v[128:131], v[80:83], v[148:151]
    s_waitcnt lgkmcnt(8)
    v_mfma_f32_16x16x32_bf16 v[152:155], v[132:135], v[80:83], v[152:155]
    s_waitcnt lgkmcnt(7)
    v_mfma_f32_16x16x32_bf16 v[156:159], v[136:139], v[80:83], v[156:159]
    s_waitcnt lgkmcnt(6)
    v_mfma_f32_16x16x32_bf16 v[160:163], v[140:143], v[80:83], v[160:163]
    s_waitcnt lgkmcnt(5)
    v_mfma_f32_16x16x32_bf16 v[164:167], v[144:147], v[80:83], v[164:167]
    s_waitcnt lgkmcnt(4)
    v_mfma_f32_16x16x32_bf16 v[148:151], v[88:91], v[84:87], v[148:151]
    s_waitcnt lgkmcnt(3)
    v_mfma_f32_16x16x32_bf16 v[152:155], v[92:95], v[84:87], v[152:155]
    s_waitcnt lgkmcnt(2)
    v_mfma_f32_16x16x32_bf16 v[156:159], v[96:99], v[84:87], v[156:159]
    s_waitcnt lgkmcnt(1)
    v_mfma_f32_16x16x32_bf16 v[160:163], v[100:103], v[84:87], v[160:163]
    s_waitcnt lgkmcnt(0)
    v_mfma_f32_16x16x32_bf16 v[164:167], v[104:107], v[84:87], v[164:167]
    s_mul_i32 s17, s53, 5120
    s_add_u32 s17, s17, 122880
    v_add_u32 v5, s17, v1
    v_lshlrev_b32 v6, 5, v241
    v_add_u32 v6, 159744, v6
    v_lshlrev_b32 v7, 4, v241
    v_add_u32 v7, 160000, v7
    s_cmp_eq_u32 s52, 0
    s_nop 0
    s_cbranch_scc1 Lwk1_10
    ds_write_b128 v5, v[148:151] offset:0
    ds_write_b128 v5, v[152:155] offset:1024
    ds_write_b128 v5, v[156:159] offset:2048
    ds_write_b128 v5, v[160:163] offset:3072
    ds_write_b128 v5, v[164:167] offset:4096
Lwk1_10:
    ds_read_b128 v[20:23], v6 offset:0
    ds_read_b128 v[24:27], v6 offset:16
    ds_read_b128 v[28:31], v6 offset:128
    ds_read_b128 v[32:35], v6 offset:144
    ds_read_b128 v[36:39], v7
    s_waitcnt lgkmcnt(0)
    s_barrier
    s_mul_i32 s15, s27, 143360
    s_add_u32 s15, s15, s9
    s_add_u32 s15, s15, 19922944
    s_lshr_b32 s18, s25, 2
    s_lshl_b32 s18, s18, 8
    s_add_u32 s18, s18, 403456
    s_lshr_b32 s19, s27, 2
    s_lshl_b32 s19, s19, 8
    s_add_u32 s19, s19, 399360
    s_cmp_eq_u32 s52, 1
    s_cbranch_scc1 L3_wk1
    ds_read_b128 v[68:71], v5 offset:0
    ds_read_b128 v[72:75], v5 offset:1024
    ds_read_b128 v[76:79], v5 offset:2048
    ds_read_b128 v[80:83], v5 offset:3072
    ds_read_b128 v[84:87], v5 offset:4096
    v_lshlrev_b32 v48, 16, v8
    v_and_b32 v49, 0xffff0000, v8
    v_lshlrev_b32 v50, 16, v9
    v_and_b32 v51, 0xffff0000, v9
    v_lshlrev_b32 v52, 16, v10
    v_and_b32 v53, 0xffff0000, v10
    v_lshlrev_b32 v54, 16, v11
    v_and_b32 v55, 0xffff0000, v11
    v_lshlrev_b32 v56, 16, v12
    v_and_b32 v57, 0xffff0000, v12
    v_lshlrev_b32 v58, 16, v13
    v_and_b32 v59, 0xffff0000, v13
    v_lshlrev_b32 v60, 16, v14
    v_and_b32 v61, 0xffff0000, v14
    v_lshlrev_b32 v62, 16, v15
    v_and_b32 v63, 0xffff0000, v15
    v_lshlrev_b32 v64, 16, v16
    v_and_b32 v65, 0xffff0000, v16
    v_lshlrev_b32 v66, 16, v17
    v_and_b32 v67, 0xffff0000, v17
    s_waitcnt lgkmcnt(4)
    v_pk_add_f32 v[148:149], v[148:149], v[68:69]
    v_pk_add_f32 v[150:151], v[150:151], v[70:71]
    s_waitcnt lgkmcnt(3)
    v_pk_add_f32 v[152:153], v[152:153], v[72:73]
    v_pk_add_f32 v[154:155], v[154:155], v[74:75]
    s_waitcnt lgkmcnt(2)
    v_pk_add_f32 v[156:157], v[156:157], v[76:77]
    v_pk_add_f32 v[158:159], v[158:159], v[78:79]
    s_waitcnt lgkmcnt(1)
    v_pk_add_f32 v[160:161], v[160:161], v[80:81]
    v_pk_add_f32 v[162:163], v[162:163], v[82:83]
    s_waitcnt lgkmcnt(0)
    v_pk_add_f32 v[164:165], v[164:165], v[84:85]
    v_pk_add_f32 v[166:167], v[166:167], v[86:87]
    v_pk_fma_f32 v[48:49], v[148:149], v[20:21], v[48:49]
    v_pk_fma_f32 v[50:51], v[150:151], v[22:23], v[50:51]
    v_pk_fma_f32 v[52:53], v[152:153], v[24:25], v[52:53]
    v_pk_fma_f32 v[54:55], v[154:155], v[26:27], v[54:55]
    v_pk_fma_f32 v[56:57], v[156:157], v[28:29], v[56:57]
    v_pk_fma_f32 v[58:59], v[158:159], v[30:31], v[58:59]
    v_pk_fma_f32 v[60:61], v[160:161], v[32:33], v[60:61]
    v_pk_fma_f32 v[62:63], v[162:163], v[34:35], v[62:63]
    v_pk_fma_f32 v[64:65], v[164:165], v[36:37], v[64:65]
    v_pk_fma_f32 v[66:67], v[166:167], v[38:39], v[66:67]
    v_cvt_pk_bf16_f32 v8, v48, v49
    v_cvt_pk_bf16_f32 v9, v50, v51
    v_cvt_pk_bf16_f32 v10, v52, v53
    v_cvt_pk_bf16_f32 v11, v54, v55
    v_cvt_pk_bf16_f32 v12, v56, v57
    v_cvt_pk_bf16_f32 v13, v58, v59
    v_cvt_pk_bf16_f32 v14, v60, v61
    v_cvt_pk_bf16_f32 v15, v62, v63
    v_cvt_pk_bf16_f32 v16, v64, v65
    v_cvt_pk_bf16_f32 v17, v66, v67
    s_mul_i32 s17, s25, 2560
    s_add_u32 s17, s17, s31
    s_add_u32 s17, s17, 17301504
    buffer_store_dwordx4 v[8:11], v1, s[4:7], s17 offen sc1
    buffer_store_dwordx4 v[12:15], v1, s[4:7], s17 offen offset:1024 sc1
    buffer_store_dwordx2 v[16:17], v248, s[4:7], s17 offen offset:2048 sc1
    v_lshlrev_b32 v48, 16, v8
    v_and_b32 v49, 0xffff0000, v8
    v_lshlrev_b32 v50, 16, v9
    v_and_b32 v51, 0xffff0000, v9
    v_lshlrev_b32 v52, 16, v10
    v_and_b32 v53, 0xffff0000, v10
    v_lshlrev_b32 v54, 16, v11
    v_and_b32 v55, 0xffff0000, v11
    v_lshlrev_b32 v56, 16, v12
    v_and_b32 v57, 0xffff0000, v12
    v_lshlrev_b32 v58, 16, v13
    v_and_b32 v59, 0xffff0000, v13
    v_lshlrev_b32 v60, 16, v14
    v_and_b32 v61, 0xffff0000, v14
    v_lshlrev_b32 v62, 16, v15
    v_and_b32 v63, 0xffff0000, v15
    v_lshlrev_b32 v64, 16, v16
    v_and_b32 v65, 0xffff0000, v16
    v_lshlrev_b32 v66, 16, v17
    v_and_b32 v67, 0xffff0000, v17
    v_pk_add_f32 v[44:45], v[48:49], v[50:51]
    v_pk_mul_f32 v[46:47], v[48:49], v[48:49]
    v_pk_fma_f32 v[46:47], v[50:51], v[50:51], v[46:47]
    v_pk_add_f32 v[44:45], v[44:45], v[52:53]
    v_pk_fma_f32 v[46:47], v[52:53], v[52:53], v[46:47]
    v_pk_add_f32 v[44:45], v[44:45], v[54:55]
    v_pk_fma_f32 v[46:47], v[54:55], v[54:55], v[46:47]
    v_pk_add_f32 v[44:45], v[44:45], v[56:57]
    v_pk_fma_f32 v[46:47], v[56:57], v[56:57], v[46:47]
    v_pk_add_f32 v[44:45], v[44:45], v[58:59]
    v_pk_fma_f32 v[46:47], v[58:59], v[58:59], v[46:47]
    v_pk_add_f32 v[44:45], v[44:45], v[60:61]
    v_pk_fma_f32 v[46:47], v[60:61], v[60:61], v[46:47]
    v_pk_add_f32 v[44:45], v[44:45], v[62:63]
    v_pk_fma_f32 v[46:47], v[62:63], v[62:63], v[46:47]
    v_pk_add_f32 v[44:45], v[44:45], v[64:65]
    v_pk_fma_f32 v[46:47], v[64:65], v[64:65], v[46:47]
    v_pk_add_f32 v[44:45], v[44:45], v[66:67]
    v_pk_fma_f32 v[46:47], v[66:67], v[66:67], v[46:47]
    v_add_f32 v44, v44, v45
    v_add_f32 v45, v46, v47
    v_mov_b32 v46, v44
    v_mov_b32 v47, v45
    s_nop 0
    v_permlane16_swap_b32 v44, v46
    v_permlane16_swap_b32 v45, v47
    v_pk_add_f32 v[44:45], v[44:45], v[46:47]
    v_mov_b32 v46, v44
    v_mov_b32 v47, v45
    s_nop 0
    v_permlane32_swap_b32 v44, v46
    v_permlane32_swap_b32 v45, v47
    v_pk_add_f32 v[44:45], v[44:45], v[46:47]
    v_lshlrev_b32 v7, 3, v240
    s_lshl_b32 s17, s30, 10
    s_lshl_b32 s16, s25, 7
    s_add_u32 s17, s17, s16
    s_add_u32 s17, s17, 131072
    s_mov_b32 exec_lo, 0xffff
    s_mov_b32 exec_hi, 0
    buffer_store_dwordx2 v[44:45], v7, s[4:7], s17 offen sc1
    s_mov_b64 exec, -1
    s_waitcnt vmcnt(0)
L3_wk1:
    s_lshr_b32 s17, s24, 2
    s_lshl_b32 s17, s17, 7
    s_and_b32 s16, s24, 3
    s_lshl_b32 s16, s16, 5
    s_add_u32 s17, s17, s16
    s_lshl_b32 s16, s25, 2
    s_add_u32 s17, s17, s16
    s_add_u32 s17, s17, 397312
    s_cmp_lg_u32 s8, 7
    s_cbranch_scc1 Lpw_11
    v_lshlrev_b32 v3, 2, v0
    s_mov_b32 exec_lo, 0xfffff
    s_mov_b32 exec_hi, 0x0
    s_mov_b32 s58, 0
Lpl_12:
    buffer_load_dword v2, v3, s[4:7], s19 offen sc1
    s_add_u32 s58, s58, 1
    s_waitcnt vmcnt(0)
    v_cmp_eq_u32 vcc, 1, v2
    s_cmp_gt_u32 s58, 400000
    s_nop 3
    s_cbranch_scc1 Lpe_13
    s_cmp_eq_u64 vcc, exec
    s_cbranch_scc0 Lpl_12
Lpe_13:
    s_mov_b32 exec_lo, 0xffffffff
    s_mov_b32 exec_hi, 0xffff
    s_mov_b32 s58, 0
Lpl_14:
    buffer_load_dword v2, v3, s[4:7], s18 offen sc1
    s_add_u32 s58, s58, 1
    s_waitcnt vmcnt(0)
    v_cmp_eq_u32 vcc, 1, v2
    s_cmp_gt_u32 s58, 400000
    s_nop 3
    s_cbranch_scc1 Lpe_15
    s_cmp_eq_u64 vcc, exec
    s_cbranch_scc0 Lpl_14
Lpe_15:
    s_mov_b64 exec, -1
Lpw_11:
    s_barrier
    s_cmp_lg_u32 s8, 7
    s_cbranch_scc1 Lsf_16
    v_mov_b32 v2, 1
    v_mov_b32 v3, 0
    s_mov_b64 exec, 1
    buffer_store_dword v2, v3, s[4:7], s17 offen sc1
    s_mov_b64 exec, -1
Lsf_16:
    s_cmp_ge_u32 s27, 31
    s_cbranch_scc1 L4_skip
    s_cmp_ge_u32 s8, 4
    s_cbranch_scc1 L4_nocs
    v_lshlrev_b32 v5, 2, v250
    s_mul_i32 s17, s27, 20480
    s_add_u32 s17, s17, 35651584
    buffer_load_dword v8, v5, s[4:7], s17 offen offset:0 sc1
    buffer_load_dword v9, v5, s[4:7], s17 offen offset:1024 sc1
    buffer_load_dword v10, v5, s[4:7], s17 offen offset:2048 sc1
    buffer_load_dword v11, v5, s[4:7], s17 offen offset:3072 sc1
    s_add_u32 s17, s17, 4096
    buffer_load_dword v12, v5, s[4:7], s17 offen offset:0 sc1
    buffer_load_dword v13, v5, s[4:7], s17 offen offset:1024 sc1
    buffer_load_dword v14, v5, s[4:7], s17 offen offset:2048 sc1
    buffer_load_dword v15, v5, s[4:7], s17 offen offset:3072 sc1
    s_add_u32 s17, s17, 4096
    buffer_load_dword v16, v5, s[4:7], s17 offen offset:0 sc1
    buffer_load_dword v17, v5, s[4:7], s17 offen offset:1024 sc1
    buffer_load_dword v18, v5, s[4:7], s17 offen offset:2048 sc1
    buffer_load_dword v19, v5, s[4:7], s17 offen offset:3072 sc1
    s_add_u32 s17, s17, 4096
    buffer_load_dword v20, v5, s[4:7], s17 offen offset:0 sc1
    buffer_load_dword v21, v5, s[4:7], s17 offen offset:1024 sc1
    buffer_load_dword v22, v5, s[4:7], s17 offen offset:2048 sc1
    buffer_load_dword v23, v5, s[4:7], s17 offen offset:3072 sc1
    s_add_u32 s17, s17, 4096
    buffer_load_dword v24, v5, s[4:7], s17 offen offset:0 sc1
    buffer_load_dword v25, v5, s[4:7], s17 offen offset:1024 sc1
    buffer_load_dword v26, v5, s[4:7], s17 offen offset:2048 sc1
    buffer_load_dword v27, v5, s[4:7], s17 offen offset:3072 sc1
    s_add_u32 s17, s17, 4096
L4_nocs:
    s_cmp_eq_u32 s8, 7
    s_cbranch_scc1 Ld7_17
    s_add_u32 m0, s9, 0
    s_nop 0
    buffer_load_dwordx4 v1, s[4:7], s15 offen sc1 lds
    s_add_u32 s15, s15, 7168
    s_add_u32 m0, s9, 7168
    s_nop 0
    buffer_load_dwordx4 v1, s[4:7], s15 offen sc1 lds
    s_add_u32 s15, s15, 7168
    s_add_u32 m0, s9, 14336
    s_nop 0
    buffer_load_dwordx4 v1, s[4:7], s15 offen sc1 lds
    s_add_u32 s15, s15, 7168
    s_add_u32 m0, s9, 21504
    s_nop 0
    buffer_load_dwordx4 v1, s[4:7], s15 offen sc1 lds
    s_add_u32 s15, s15, 7168
    s_add_u32 m0, s9, 28672
    s_nop 0
    buffer_load_dwordx4 v1, s[4:7], s15 offen sc1 lds
    s_add_u32 s15, s15, 7168
    s_add_u32 m0, s9, 35840
    s_nop 0
    buffer_load_dwordx4 v1, s[4:7], s15 offen sc1 lds
    s_add_u32 s15, s15, 7168
    s_add_u32 m0, s9, 43008
    s_nop 0
    buffer_load_dwordx4 v1, s[4:7], s15 offen sc1 lds
    s_add_u32 s15, s15, 7168
    s_add_u32 m0, s9, 50176
    s_nop 0
    buffer_load_dwordx4 v1, s[4:7], s15 offen sc1 lds
    s_add_u32 s15, s15, 7168
    s_add_u32 m0, s9, 57344
    s_nop 0
    buffer_load_dwordx4 v1, s[4:7], s15 offen sc1 lds
    s_add_u32 s15, s15, 7168
    s_add_u32 m0, s9, 64512
    s_nop 0
    buffer_load_dwordx4 v1, s[4:7], s15 offen sc1 lds
    s_add_u32 s15, s15, 7168
    s_add_u32 m0, s9, 71680
    s_nop 0
    buffer_load_dwordx4 v1, s[4:7], s15 offen sc1 lds
    s_add_u32 s15, s15, 7168
    s_add_u32 m0, s9, 78848
    s_nop 0
    buffer_load_dwordx4 v1, s[4:7], s15 offen sc1 lds
    s_add_u32 s15, s15, 7168
    s_add_u32 m0, s9, 86016
    s_nop 0
    buffer_load_dwordx4 v1, s[4:7], s15 offen sc1 lds
    s_add_u32 s15, s15, 7168
    s_add_u32 m0, s9, 93184
    s_nop 0
    buffer_load_dwordx4 v1, s[4:7], s15 offen sc1 lds
    s_add_u32 s15, s15, 7168
    s_add_u32 m0, s9, 100352
    s_nop 0
    buffer_load_dwordx4 v1, s[4:7], s15 offen sc1 lds
    s_add_u32 s15, s15, 7168
    s_add_u32 m0, s9, 107520
    s_nop 0
    buffer_load_dwordx4 v1, s[4:7], s15 offen sc1 lds
    s_add_u32 s15, s15, 7168
    s_add_u32 m0, s9, 114688
    s_nop 0
    buffer_load_dwordx4 v1, s[4:7], s15 offen sc1 lds
    s_add_u32 s15, s15, 7168
    s_add_u32 m0, s9, 121856
    s_nop 0
    buffer_load_dwordx4 v1, s[4:7], s15 offen sc1 lds
    s_add_u32 s15, s15, 7168
    s_add_u32 m0, s9, 129024
    s_nop 0
    buffer_load_dwordx4 v1, s[4:7], s15 offen sc1 lds
    s_add_u32 s15, s15, 7168
    s_add_u32 m0, s9, 136192
    s_nop 0
    buffer_load_dwordx4 v1, s[4:7], s15 offen sc1 lds
    s_add_u32 s15, s15, 7168
Ld7_17:
    s_cmp_ge_u32 s8, 4
    s_cbranch_scc1 L4_nocs2
    s_waitcnt vmcnt(20)
    v_add_f32 v8, v8, v24
    v_add_f32 v9, v9, v25
    v_add_f32 v10, v10, v26
    v_add_f32 v11, v11, v27
    v_add_f32 v8, v8, v16
    v_add_f32 v9, v9, v17
    v_add_f32 v10, v10, v18
    v_add_f32 v11, v11, v19
    v_add_f32 v12, v12, v20
    v_add_f32 v13, v13, v21
    v_add_f32 v14, v14, v22
    v_add_f32 v15, v15, v23
    v_add_f32 v8, v8, v12
    v_add_f32 v9, v9, v13
    v_add_f32 v10, v10, v14
    v_add_f32 v11, v11, v15
    v_add_f32 v8, v8, v10
    v_add_f32 v9, v9, v11
    v_add_f32 v8, v8, v9
    v_add_u32 v5, 161280, v5
    ds_write_b32 v5, v8
    s_nop 0
L4_nocs2:
    s_lshl_b32 s16, s26, 4
    s_lshl_b32 s12, s8, 1
    s_add_u32 s16, s16, s12
    s_mul_i32 s12, s16, 20480
    s_add_u32 s12, s12, 17301504
    s_add_u32 s13, s12, 20480
    s_lshl_b32 s17, s26, 7
    s_add_u32 s17, s17, 397312
    s_cmp_lg_u32 s8, 7
    s_cbranch_scc1 Lpw_18
    v_lshlrev_b32 v3, 2, v0
    s_mov_b32 exec_lo, 0xffffffff
    s_mov_b32 exec_hi, 0x0
    s_mov_b32 s58, 0
Lpl_19:
    buffer_load_dword v2, v3, s[4:7], s17 offen sc1
    s_add_u32 s58, s58, 1
    s_waitcnt vmcnt(0)
    v_cmp_eq_u32 vcc, 1, v2
    s_cmp_gt_u32 s58, 400000
    s_nop 3
    s_cbranch_scc1 Lpe_20
    s_cmp_eq_u64 vcc, exec
    s_cbranch_scc0 Lpl_19
Lpe_20:
    s_mov_b64 exec, -1
Lpw_18:
    s_barrier
    buffer_load_dwordx4 v[16:19], v1, s[4:7], s12 offen offset:0 sc1
    buffer_load_dwordx4 v[20:23], v1, s[4:7], s13 offen offset:0 sc1
    buffer_load_dwordx4 v[24:27], v1, s[4:7], s12 offen offset:1024 sc1
    buffer_load_dwordx4 v[28:31], v1, s[4:7], s13 offen offset:1024 sc1
    buffer_load_dwordx4 v[32:35], v1, s[4:7], s12 offen offset:2048 sc1
    buffer_load_dwordx4 v[36:39], v1, s[4:7], s13 offen offset:2048 sc1
    buffer_load_dwordx4 v[40:43], v1, s[4:7], s12 offen offset:3072 sc1
    s_add_u32 s12, s12, 4096
    buffer_load_dwordx4 v[44:47], v1, s[4:7], s13 offen offset:3072 sc1
    s_add_u32 s13, s13, 4096
    s_waitcnt vmcnt(4) lgkmcnt(0)
    s_barrier
    ds_read_b128 v[80:83], v1 offset:0
    ds_read_b128 v[84:87], v1 offset:1024
    ds_read_b128 v[88:91], v1 offset:2048
    ds_read_b128 v[92:95], v1 offset:3072
    ds_read_b128 v[96:99], v1 offset:4096
    ds_read_b128 v[100:103], v1 offset:5120
    ds_read_b128 v[104:107], v1 offset:6144
    s_waitcnt lgkmcnt(6)
    v_mfma_f32_16x16x32_bf16 v[136:139], v[80:83], v[16:19], 0
    ds_read_b128 v[108:111], v1 offset:7168
    v_mfma_f32_16x16x32_bf16 v[164:167], v[80:83], v[20:23], 0
    buffer_load_dwordx4 v[48:51], v1, s[4:7], s12 offen offset:0 sc1
    s_waitcnt lgkmcnt(6)
    v_mfma_f32_16x16x32_bf16 v[140:143], v[84:87], v[16:19], 0
    ds_read_b128 v[112:115], v1 offset:8192
    v_mfma_f32_16x16x32_bf16 v[168:171], v[84:87], v[20:23], 0
    s_waitcnt lgkmcnt(6)
    v_mfma_f32_16x16x32_bf16 v[144:147], v[88:91], v[16:19], 0
    ds_read_b128 v[116:119], v1 offset:9216
    buffer_load_dwordx4 v[52:55], v1, s[4:7], s13 offen offset:0 sc1
    v_mfma_f32_16x16x32_bf16 v[172:175], v[88:91], v[20:23], 0
    s_waitcnt lgkmcnt(6)
    v_mfma_f32_16x16x32_bf16 v[148:151], v[92:95], v[16:19], 0
    ds_read_b128 v[120:123], v1 offset:10240
    v_mfma_f32_16x16x32_bf16 v[176:179], v[92:95], v[20:23], 0
    s_waitcnt lgkmcnt(6)
    v_mfma_f32_16x16x32_bf16 v[152:155], v[96:99], v[16:19], 0
    ds_read_b128 v[124:127], v1 offset:11264
    buffer_load_dwordx4 v[56:59], v1, s[4:7], s12 offen offset:1024 sc1
    v_mfma_f32_16x16x32_bf16 v[180:183], v[96:99], v[20:23], 0
    s_waitcnt lgkmcnt(6)
    v_mfma_f32_16x16x32_bf16 v[156:159], v[100:103], v[16:19], 0
    ds_read_b128 v[128:131], v1 offset:12288
    v_mfma_f32_16x16x32_bf16 v[184:187], v[100:103], v[20:23], 0
    buffer_load_dwordx4 v[60:63], v1, s[4:7], s13 offen offset:1024 sc1
    s_waitcnt lgkmcnt(6)
    v_mfma_f32_16x16x32_bf16 v[160:163], v[104:107], v[16:19], 0
    ds_read_b128 v[132:135], v1 offset:13312
    v_mfma_f32_16x16x32_bf16 v[188:191], v[104:107], v[20:23], 0
    s_waitcnt vmcnt(4)
    s_waitcnt lgkmcnt(6)
    v_mfma_f32_16x16x32_bf16 v[136:139], v[108:111], v[24:27], v[136:139]
    ds_read_b128 v[80:83], v1 offset:14336
    v_mfma_f32_16x16x32_bf16 v[164:167], v[108:111], v[28:31], v[164:167]
    buffer_load_dwordx4 v[64:67], v1, s[4:7], s12 offen offset:2048 sc1
    s_waitcnt lgkmcnt(6)
    v_mfma_f32_16x16x32_bf16 v[140:143], v[112:115], v[24:27], v[140:143]
    ds_read_b128 v[84:87], v1 offset:15360
    v_mfma_f32_16x16x32_bf16 v[168:171], v[112:115], v[28:31], v[168:171]
    s_waitcnt lgkmcnt(6)
    v_mfma_f32_16x16x32_bf16 v[144:147], v[116:119], v[24:27], v[144:147]
    ds_read_b128 v[88:91], v1 offset:16384
    buffer_load_dwordx4 v[68:71], v1, s[4:7], s13 offen offset:2048 sc1
    v_mfma_f32_16x16x32_bf16 v[172:175], v[116:119], v[28:31], v[172:175]
    s_waitcnt lgkmcnt(6)
    v_mfma_f32_16x16x32_bf16 v[148:151], v[120:123], v[24:27], v[148:151]
    ds_read_b128 v[92:95], v1 offset:17408
    v_mfma_f32_16x16x32_bf16 v[176:179], v[120:123], v[28:31], v[176:179]
    s_waitcnt lgkmcnt(6)
    v_mfma_f32_16x16x32_bf16 v[152:155], v[124:127], v[24:27], v[152:155]
    ds_read_b128 v[96:99], v1 offset:18432
    buffer_load_dwordx4 v[72:75], v1, s[4:7], s12 offen offset:3072 sc1
    s_add_u32 s12, s12, 4096
    v_mfma_f32_16x16x32_bf16 v[180:183], v[124:127], v[28:31], v[180:183]
    s_waitcnt lgkmcnt(6)
    v_mfma_f32_16x16x32_bf16 v[156:159], v[128:131], v[24:27], v[156:159]
    ds_read_b128 v[100:103], v1 offset:19456
    v_mfma_f32_16x16x32_bf16 v[184:187], v[128:131], v[28:31], v[184:187]
    buffer_load_dwordx4 v[76:79], v1, s[4:7], s13 offen offset:3072 sc1
    s_add_u32 s13, s13, 4096
    s_waitcnt lgkmcnt(6)
    v_mfma_f32_16x16x32_bf16 v[160:163], v[132:135], v[24:27], v[160:163]
    ds_read_b128 v[104:107], v1 offset:20480
    v_mfma_f32_16x16x32_bf16 v[188:191], v[132:135], v[28:31], v[188:191]
    s_waitcnt lgkmcnt(6)
    v_mfma_f32_16x16x32_bf16 v[136:139], v[80:83], v[32:35], v[136:139]
    ds_read_b128 v[108:111], v1 offset:21504
    v_mfma_f32_16x16x32_bf16 v[164:167], v[80:83], v[36:39], v[164:167]
    buffer_load_dwordx4 v[16:19], v1, s[4:7], s12 offen offset:0 sc1
    s_waitcnt lgkmcnt(6)
    v_mfma_f32_16x16x32_bf16 v[140:143], v[84:87], v[32:35], v[140:143]
    ds_read_b128 v[112:115], v1 offset:22528
    v_mfma_f32_16x16x32_bf16 v[168:171], v[84:87], v[36:39], v[168:171]
    s_waitcnt lgkmcnt(6)
    v_mfma_f32_16x16x32_bf16 v[144:147], v[88:91], v[32:35], v[144:147]
    ds_read_b128 v[116:119], v1 offset:23552
    v_mfma_f32_16x16x32_bf16 v[172:175], v[88:91], v[36:39], v[172:175]
    s_waitcnt lgkmcnt(6)
    v_mfma_f32_16x16x32_bf16 v[148:151], v[92:95], v[32:35], v[148:151]
    ds_read_b128 v[120:123], v1 offset:24576
    v_mfma_f32_16x16x32_bf16 v[176:179], v[92:95], v[36:39], v[176:179]
    s_waitcnt lgkmcnt(6)
    v_mfma_f32_16x16x32_bf16 v[152:155], v[96:99], v[32:35], v[152:155]
    ds_read_b128 v[124:127], v1 offset:25600
    buffer_load_dwordx4 v[20:23], v1, s[4:7], s13 offen offset:0 sc1
    v_mfma_f32_16x16x32_bf16 v[180:183], v[96:99], v[36:39], v[180:183]
    s_waitcnt lgkmcnt(6)
    v_mfma_f32_16x16x32_bf16 v[156:159], v[100:103], v[32:35], v[156:159]
    ds_read_b128 v[128:131], v1 offset:26624
    v_mfma_f32_16x16x32_bf16 v[184:187], v[100:103], v[36:39], v[184:187]
    s_waitcnt lgkmcnt(6)
    v_mfma_f32_16x16x32_bf16 v[160:163], v[104:107], v[32:35], v[160:163]
    ds_read_b128 v[132:135], v1 offset:27648
    v_mfma_f32_16x16x32_bf16 v[188:191], v[104:107], v[36:39], v[188:191]
    s_waitcnt vmcnt(6)
    s_waitcnt lgkmcnt(6)
    v_mfma_f32_16x16x32_bf16 v[136:139], v[108:111], v[40:43], v[136:139]
    ds_read_b128 v[80:83], v1 offset:28672
    v_mfma_f32_16x16x32_bf16 v[164:167], v[108:111], v[44:47], v[164:167]
    buffer_load_dwordx4 v[24:27], v1, s[4:7], s12 offen offset:1024 sc1
    s_waitcnt lgkmcnt(6)
    v_mfma_f32_16x16x32_bf16 v[140:143], v[112:115], v[40:43], v[140:143]
    ds_read_b128 v[84:87], v1 offset:29696
    v_mfma_f32_16x16x32_bf16 v[168:171], v[112:115], v[44:47], v[168:171]
    s_waitcnt lgkmcnt(6)
    v_mfma_f32_16x16x32_bf16 v[144:147], v[116:119], v[40:43], v[144:147]
    ds_read_b128 v[88:91], v1 offset:30720
    v_mfma_f32_16x16x32_bf16 v[172:175], v[116:119], v[44:47], v[172:175]
    s_waitcnt lgkmcnt(6)
    v_mfma_f32_16x16x32_bf16 v[148:151], v[120:123], v[40:43], v[148:151]
    ds_read_b128 v[92:95], v1 offset:31744
    v_mfma_f32_16x16x32_bf16 v[176:179], v[120:123], v[44:47], v[176:179]
    s_waitcnt lgkmcnt(6)
    v_mfma_f32_16x16x32_bf16 v[152:155], v[124:127], v[40:43], v[152:155]
    ds_read_b128 v[96:99], v1 offset:32768
    buffer_load_dwordx4 v[28:31], v1, s[4:7], s13 offen offset:1024 sc1
    v_mfma_f32_16x16x32_bf16 v[180:183], v[124:127], v[44:47], v[180:183]
    s_waitcnt lgkmcnt(6)
    v_mfma_f32_16x16x32_bf16 v[156:159], v[128:131], v[40:43], v[156:159]
    ds_read_b128 v[100:103], v1 offset:33792
    v_mfma_f32_16x16x32_bf16 v[184:187], v[128:131], v[44:47], v[184:187]
    s_waitcnt lgkmcnt(6)
    v_mfma_f32_16x16x32_bf16 v[160:163], v[132:135], v[40:43], v[160:163]
    ds_read_b128 v[104:107], v1 offset:34816
    v_mfma_f32_16x16x32_bf16 v[188:191], v[132:135], v[44:47], v[188:191]
    s_waitcnt lgkmcnt(6)
    v_mfma_f32_16x16x32_bf16 v[136:139], v[80:83], v[48:51], v[136:139]
    ds_read_b128 v[108:111], v1 offset:35840
    v_mfma_f32_16x16x32_bf16 v[164:167], v[80:83], v[52:55], v[164:167]
    buffer_load_dwordx4 v[32:35], v1, s[4:7], s12 offen offset:2048 sc1
    s_waitcnt lgkmcnt(6)
    v_mfma_f32_16x16x32_bf16 v[140:143], v[84:87], v[48:51], v[140:143]
    ds_read_b128 v[112:115], v1 offset:36864
    v_mfma_f32_16x16x32_bf16 v[168:171], v[84:87], v[52:55], v[168:171]
    s_waitcnt lgkmcnt(6)
    v_mfma_f32_16x16x32_bf16 v[144:147], v[88:91], v[48:51], v[144:147]
    ds_read_b128 v[116:119], v1 offset:37888
    v_mfma_f32_16x16x32_bf16 v[172:175], v[88:91], v[52:55], v[172:175]
    s_waitcnt lgkmcnt(6)
    v_mfma_f32_16x16x32_bf16 v[148:151], v[92:95], v[48:51], v[148:151]
    ds_read_b128 v[120:123], v1 offset:38912
    v_mfma_f32_16x16x32_bf16 v[176:179], v[92:95], v[52:55], v[176:179]
    s_waitcnt lgkmcnt(6)
    v_mfma_f32_16x16x32_bf16 v[152:155], v[96:99], v[48:51], v[152:155]
    ds_read_b128 v[124:127], v1 offset:39936
    buffer_load_dwordx4 v[36:39], v1, s[4:7], s13 offen offset:2048 sc1
    v_mfma_f32_16x16x32_bf16 v[180:183], v[96:99], v[52:55], v[180:183]
    s_waitcnt lgkmcnt(6)
    v_mfma_f32_16x16x32_bf16 v[156:159], v[100:103], v[48:51], v[156:159]
    ds_read_b128 v[128:131], v1 offset:40960
    v_mfma_f32_16x16x32_bf16 v[184:187], v[100:103], v[52:55], v[184:187]
    s_waitcnt lgkmcnt(6)
    v_mfma_f32_16x16x32_bf16 v[160:163], v[104:107], v[48:51], v[160:163]
    ds_read_b128 v[132:135], v1 offset:41984
    v_mfma_f32_16x16x32_bf16 v[188:191], v[104:107], v[52:55], v[188:191]
    s_waitcnt vmcnt(6)
    s_waitcnt lgkmcnt(6)
    v_mfma_f32_16x16x32_bf16 v[136:139], v[108:111], v[56:59], v[136:139]
    ds_read_b128 v[80:83], v1 offset:43008
    v_mfma_f32_16x16x32_bf16 v[164:167], v[108:111], v[60:63], v[164:167]
    buffer_load_dwordx4 v[40:43], v1, s[4:7], s12 offen offset:3072 sc1
    s_add_u32 s12, s12, 4096
    s_waitcnt lgkmcnt(6)
    v_mfma_f32_16x16x32_bf16 v[140:143], v[112:115], v[56:59], v[140:143]
    ds_read_b128 v[84:87], v1 offset:44032
    v_mfma_f32_16x16x32_bf16 v[168:171], v[112:115], v[60:63], v[168:171]
    s_waitcnt lgkmcnt(6)
    v_mfma_f32_16x16x32_bf16 v[144:147], v[116:119], v[56:59], v[144:147]
    ds_read_b128 v[88:91], v1 offset:45056
    v_mfma_f32_16x16x32_bf16 v[172:175], v[116:119], v[60:63], v[172:175]
    s_waitcnt lgkmcnt(6)
    v_mfma_f32_16x16x32_bf16 v[148:151], v[120:123], v[56:59], v[148:151]
    ds_read_b128 v[92:95], v1 offset:46080
    v_mfma_f32_16x16x32_bf16 v[176:179], v[120:123], v[60:63], v[176:179]
    s_waitcnt lgkmcnt(6)
    v_mfma_f32_16x16x32_bf16 v[152:155], v[124:127], v[56:59], v[152:155]
    ds_read_b128 v[96:99], v1 offset:47104
    buffer_load_dwordx4 v[44:47], v1, s[4:7], s13 offen offset:3072 sc1
    s_add_u32 s13, s13, 4096
    v_mfma_f32_16x16x32_bf16 v[180:183], v[124:127], v[60:63], v[180:183]
    s_waitcnt lgkmcnt(6)
    v_mfma_f32_16x16x32_bf16 v[156:159], v[128:131], v[56:59], v[156:159]
    ds_read_b128 v[100:103], v1 offset:48128
    v_mfma_f32_16x16x32_bf16 v[184:187], v[128:131], v[60:63], v[184:187]
    s_waitcnt lgkmcnt(6)
    v_mfma_f32_16x16x32_bf16 v[160:163], v[132:135], v[56:59], v[160:163]
    ds_read_b128 v[104:107], v1 offset:49152
    v_mfma_f32_16x16x32_bf16 v[188:191], v[132:135], v[60:63], v[188:191]
    s_waitcnt lgkmcnt(6)
    v_mfma_f32_16x16x32_bf16 v[136:139], v[80:83], v[64:67], v[136:139]
    ds_read_b128 v[108:111], v1 offset:50176
    v_mfma_f32_16x16x32_bf16 v[164:167], v[80:83], v[68:71], v[164:167]
    buffer_load_dwordx4 v[48:51], v1, s[4:7], s12 offen offset:0 sc1
    s_waitcnt lgkmcnt(6)
    v_mfma_f32_16x16x32_bf16 v[140:143], v[84:87], v[64:67], v[140:143]
    ds_read_b128 v[112:115], v1 offset:51200
    v_mfma_f32_16x16x32_bf16 v[168:171], v[84:87], v[68:71], v[168:171]
    s_waitcnt lgkmcnt(6)
    v_mfma_f32_16x16x32_bf16 v[144:147], v[88:91], v[64:67], v[144:147]
    ds_read_b128 v[116:119], v1 offset:52224
    v_mfma_f32_16x16x32_bf16 v[172:175], v[88:91], v[68:71], v[172:175]
    s_waitcnt lgkmcnt(6)
    v_mfma_f32_16x16x32_bf16 v[148:151], v[92:95], v[64:67], v[148:151]
    ds_read_b128 v[120:123], v1 offset:53248
    v_mfma_f32_16x16x32_bf16 v[176:179], v[92:95], v[68:71], v[176:179]
    s_waitcnt lgkmcnt(6)
    v_mfma_f32_16x16x32_bf16 v[152:155], v[96:99], v[64:67], v[152:155]
    ds_read_b128 v[124:127], v1 offset:54272
    buffer_load_dwordx4 v[52:55], v1, s[4:7], s13 offen offset:0 sc1
    v_mfma_f32_16x16x32_bf16 v[180:183], v[96:99], v[68:71], v[180:183]
    s_waitcnt lgkmcnt(6)
    v_mfma_f32_16x16x32_bf16 v[156:159], v[100:103], v[64:67], v[156:159]
    ds_read_b128 v[128:131], v1 offset:55296
    v_mfma_f32_16x16x32_bf16 v[184:187], v[100:103], v[68:71], v[184:187]
    s_waitcnt lgkmcnt(6)
    v_mfma_f32_16x16x32_bf16 v[160:163], v[104:107], v[64:67], v[160:163]
    ds_read_b128 v[132:135], v1 offset:56320
    v_mfma_f32_16x16x32_bf16 v[188:191], v[104:107], v[68:71], v[188:191]
    s_waitcnt vmcnt(6)
    s_waitcnt lgkmcnt(6)
    v_mfma_f32_16x16x32_bf16 v[136:139], v[108:111], v[72:75], v[136:139]
    ds_read_b128 v[80:83], v1 offset:57344
    v_mfma_f32_16x16x32_bf16 v[164:167], v[108:111], v[76:79], v[164:167]
    buffer_load_dwordx4 v[56:59], v1, s[4:7], s12 offen offset:1024 sc1
    s_waitcnt lgkmcnt(6)
    v_mfma_f32_16x16x32_bf16 v[140:143], v[112:115], v[72:75], v[140:143]
    ds_read_b128 v[84:87], v1 offset:58368
    v_mfma_f32_16x16x32_bf16 v[168:171], v[112:115], v[76:79], v[168:171]
    s_waitcnt lgkmcnt(6)
    v_mfma_f32_16x16x32_bf16 v[144:147], v[116:119], v[72:75], v[144:147]
    ds_read_b128 v[88:91], v1 offset:59392
    v_mfma_f32_16x16x32_bf16 v[172:175], v[116:119], v[76:79], v[172:175]
    s_waitcnt lgkmcnt(6)
    v_mfma_f32_16x16x32_bf16 v[148:151], v[120:123], v[72:75], v[148:151]
    ds_read_b128 v[92:95], v1 offset:60416
    v_mfma_f32_16x16x32_bf16 v[176:179], v[120:123], v[76:79], v[176:179]
    s_waitcnt lgkmcnt(6)
    v_mfma_f32_16x16x32_bf16 v[152:155], v[124:127], v[72:75], v[152:155]
    ds_read_b128 v[96:99], v1 offset:61440
    buffer_load_dwordx4 v[60:63], v1, s[4:7], s13 offen offset:1024 sc1
    v_mfma_f32_16x16x32_bf16 v[180:183], v[124:127], v[76:79], v[180:183]
    s_waitcnt lgkmcnt(6)
    v_mfma_f32_16x16x32_bf16 v[156:159], v[128:131], v[72:75], v[156:159]
    ds_read_b128 v[100:103], v1 offset:62464
    v_mfma_f32_16x16x32_bf16 v[184:187], v[128:131], v[76:79], v[184:187]
    s_waitcnt lgkmcnt(6)
    v_mfma_f32_16x16x32_bf16 v[160:163], v[132:135], v[72:75], v[160:163]
    ds_read_b128 v[104:107], v1 offset:63488
    v_mfma_f32_16x16x32_bf16 v[188:191], v[132:135], v[76:79], v[188:191]
    s_waitcnt lgkmcnt(6)
    v_mfma_f32_16x16x32_bf16 v[136:139], v[80:83], v[16:19], v[136:139]
    ds_read_b128 v[108:111], v1 offset:64512
    v_mfma_f32_16x16x32_bf16 v[164:167], v[80:83], v[20:23], v[164:167]
    buffer_load_dwordx4 v[64:67], v1, s[4:7], s12 offen offset:2048 sc1
    s_waitcnt lgkmcnt(6)
    v_mfma_f32_16x16x32_bf16 v[140:143], v[84:87], v[16:19], v[140:143]
    ds_read_b128 v[112:115], v254 offset:0
    v_mfma_f32_16x16x32_bf16 v[168:171], v[84:87], v[20:23], v[168:171]
    s_waitcnt lgkmcnt(6)
    v_mfma_f32_16x16x32_bf16 v[144:147], v[88:91], v[16:19], v[144:147]
    ds_read_b128 v[116:119], v254 offset:1024
    v_mfma_f32_16x16x32_bf16 v[172:175], v[88:91], v[20:23], v[172:175]
    buffer_load_dwordx4 v[68:71], v1, s[4:7], s13 offen offset:2048 sc1
    s_waitcnt lgkmcnt(6)
    v_mfma_f32_16x16x32_bf16 v[148:151], v[92:95], v[16:19], v[148:151]
    ds_read_b128 v[120:123], v254 offset:2048
    v_mfma_f32_16x16x32_bf16 v[176:179], v[92:95], v[20:23], v[176:179]
    s_waitcnt lgkmcnt(6)
    v_mfma_f32_16x16x32_bf16 v[152:155], v[96:99], v[16:19], v[152:155]
    ds_read_b128 v[124:127], v254 offset:3072
    v_mfma_f32_16x16x32_bf16 v[180:183], v[96:99], v[20:23], v[180:183]
    s_waitcnt lgkmcnt(6)
    v_mfma_f32_16x16x32_bf16 v[156:159], v[100:103], v[16:19], v[156:159]
    ds_read_b128 v[128:131], v254 offset:4096
    v_lshlrev_b32 v6, 8, v241
    v_lshl_add_u32 v6, v240, 3, v6
    s_lshl_b32 s17, s16, 10
    s_add_u32 s17, s17, 131072
    buffer_load_dwordx2 v[8:9], v6, s[4:7], s17 offen offset:0 sc1
    buffer_load_dwordx2 v[10:11], v6, s[4:7], s17 offen offset:128 sc1
    buffer_load_dwordx2 v[12:13], v6, s[4:7], s17 offen offset:1024 sc1
    buffer_load_dwordx2 v[14:15], v6, s[4:7], s17 offen offset:1152 sc1
    v_lshlrev_b32 v7, 4, v241
    v_add_u32 v7, 161280, v7
    v_mfma_f32_16x16x32_bf16 v[184:187], v[100:103], v[20:23], v[184:187]
    s_waitcnt lgkmcnt(6)
    v_mfma_f32_16x16x32_bf16 v[160:163], v[104:107], v[16:19], v[160:163]
    ds_read_b128 v[132:135], v254 offset:5120
    v_mfma_f32_16x16x32_bf16 v[188:191], v[104:107], v[20:23], v[188:191]
    s_waitcnt vmcnt(10)
    s_waitcnt lgkmcnt(6)
    v_mfma_f32_16x16x32_bf16 v[136:139], v[108:111], v[24:27], v[136:139]
    ds_read_b128 v[80:83], v254 offset:6144
    v_mfma_f32_16x16x32_bf16 v[164:167], v[108:111], v[28:31], v[164:167]
    buffer_load_dwordx4 v[72:75], v1, s[4:7], s12 offen offset:3072 sc1
    s_add_u32 s12, s12, 4096
    s_waitcnt lgkmcnt(6)
    v_mfma_f32_16x16x32_bf16 v[140:143], v[112:115], v[24:27], v[140:143]
    ds_read_b128 v[84:87], v254 offset:7168
    v_mfma_f32_16x16x32_bf16 v[168:171], v[112:115], v[28:31], v[168:171]
    s_waitcnt lgkmcnt(6)
    v_mfma_f32_16x16x32_bf16 v[144:147], v[116:119], v[24:27], v[144:147]
    ds_read_b128 v[88:91], v254 offset:8192
    v_mfma_f32_16x16x32_bf16 v[172:175], v[116:119], v[28:31], v[172:175]
    s_waitcnt lgkmcnt(6)
    v_mfma_f32_16x16x32_bf16 v[148:151], v[120:123], v[24:27], v[148:151]
    ds_read_b128 v[92:95], v254 offset:9216
    v_mfma_f32_16x16x32_bf16 v[176:179], v[120:123], v[28:31], v[176:179]
    s_waitcnt lgkmcnt(6)
    v_mfma_f32_16x16x32_bf16 v[152:155], v[124:127], v[24:27], v[152:155]
    ds_read_b128 v[96:99], v254 offset:10240
    buffer_load_dwordx4 v[76:79], v1, s[4:7], s13 offen offset:3072 sc1
    s_add_u32 s13, s13, 4096
    v_mfma_f32_16x16x32_bf16 v[180:183], v[124:127], v[28:31], v[180:183]
    s_waitcnt lgkmcnt(6)
    v_mfma_f32_16x16x32_bf16 v[156:159], v[128:131], v[24:27], v[156:159]
    ds_read_b128 v[100:103], v254 offset:11264
    v_mfma_f32_16x16x32_bf16 v[184:187], v[128:131], v[28:31], v[184:187]
    s_waitcnt lgkmcnt(6)
    v_mfma_f32_16x16x32_bf16 v[160:163], v[132:135], v[24:27], v[160:163]
    ds_read_b128 v[104:107], v254 offset:12288
    v_mfma_f32_16x16x32_bf16 v[188:191], v[132:135], v[28:31], v[188:191]
    s_waitcnt lgkmcnt(6)
    v_mfma_f32_16x16x32_bf16 v[136:139], v[80:83], v[32:35], v[136:139]
    ds_read_b128 v[108:111], v254 offset:13312
    v_mfma_f32_16x16x32_bf16 v[164:167], v[80:83], v[36:39], v[164:167]
    buffer_load_dwordx4 v[16:19], v1, s[4:7], s12 offen offset:0 sc1
    s_waitcnt lgkmcnt(6)
    v_mfma_f32_16x16x32_bf16 v[140:143], v[84:87], v[32:35], v[140:143]
    ds_read_b128 v[112:115], v254 offset:14336
    v_mfma_f32_16x16x32_bf16 v[168:171], v[84:87], v[36:39], v[168:171]
    s_waitcnt lgkmcnt(6)
    v_mfma_f32_16x16x32_bf16 v[144:147], v[88:91], v[32:35], v[144:147]
    ds_read_b128 v[116:119], v254 offset:15360
    v_mfma_f32_16x16x32_bf16 v[172:175], v[88:91], v[36:39], v[172:175]
    s_waitcnt lgkmcnt(6)
    v_mfma_f32_16x16x32_bf16 v[148:151], v[92:95], v[32:35], v[148:151]
    ds_read_b128 v[120:123], v254 offset:16384
    v_mfma_f32_16x16x32_bf16 v[176:179], v[92:95], v[36:39], v[176:179]
    s_waitcnt lgkmcnt(6)
    v_mfma_f32_16x16x32_bf16 v[152:155], v[96:99], v[32:35], v[152:155]
    ds_read_b128 v[124:127], v254 offset:17408
    buffer_load_dwordx4 v[20:23], v1, s[4:7], s13 offen offset:0 sc1
    v_mfma_f32_16x16x32_bf16 v[180:183], v[96:99], v[36:39], v[180:183]
    s_waitcnt lgkmcnt(6)
    v_mfma_f32_16x16x32_bf16 v[156:159], v[100:103], v[32:35], v[156:159]
    ds_read_b128 v[128:131], v254 offset:18432
    v_mfma_f32_16x16x32_bf16 v[184:187], v[100:103], v[36:39], v[184:187]
    s_waitcnt lgkmcnt(6)
    v_mfma_f32_16x16x32_bf16 v[160:163], v[104:107], v[32:35], v[160:163]
    ds_read_b128 v[132:135], v254 offset:19456
    v_mfma_f32_16x16x32_bf16 v[188:191], v[104:107], v[36:39], v[188:191]
    s_waitcnt vmcnt(10)
    s_waitcnt lgkmcnt(6)
    v_mfma_f32_16x16x32_bf16 v[136:139], v[108:111], v[40:43], v[136:139]
    ds_read_b128 v[80:83], v254 offset:20480
    v_mfma_f32_16x16x32_bf16 v[164:167], v[108:111], v[44:47], v[164:167]
    buffer_load_dwordx4 v[24:27], v1, s[4:7], s12 offen offset:1024 sc1
    s_waitcnt lgkmcnt(6)
    v_mfma_f32_16x16x32_bf16 v[140:143], v[112:115], v[40:43], v[140:143]
    ds_read_b128 v[84:87], v254 offset:21504
    v_mfma_f32_16x16x32_bf16 v[168:171], v[112:115], v[44:47], v[168:171]
    s_waitcnt lgkmcnt(6)
    v_mfma_f32_16x16x32_bf16 v[144:147], v[116:119], v[40:43], v[144:147]
    ds_read_b128 v[88:91], v254 offset:22528
    v_mfma_f32_16x16x32_bf16 v[172:175], v[116:119], v[44:47], v[172:175]
    s_waitcnt lgkmcnt(6)
    v_mfma_f32_16x16x32_bf16 v[148:151], v[120:123], v[40:43], v[148:151]
    ds_read_b128 v[92:95], v254 offset:23552
    v_mfma_f32_16x16x32_bf16 v[176:179], v[120:123], v[44:47], v[176:179]
    s_waitcnt lgkmcnt(6)
    v_mfma_f32_16x16x32_bf16 v[152:155], v[124:127], v[40:43], v[152:155]
    ds_read_b128 v[96:99], v254 offset:24576
    buffer_load_dwordx4 v[28:31], v1, s[4:7], s13 offen offset:1024 sc1
    v_mfma_f32_16x16x32_bf16 v[180:183], v[124:127], v[44:47], v[180:183]
    s_waitcnt lgkmcnt(6)
    v_mfma_f32_16x16x32_bf16 v[156:159], v[128:131], v[40:43], v[156:159]
    ds_read_b128 v[100:103], v254 offset:25600
    v_mfma_f32_16x16x32_bf16 v[184:187], v[128:131], v[44:47], v[184:187]
    s_waitcnt lgkmcnt(6)
    v_mfma_f32_16x16x32_bf16 v[160:163], v[132:135], v[40:43], v[160:163]
    ds_read_b128 v[104:107], v254 offset:26624
    v_mfma_f32_16x16x32_bf16 v[188:191], v[132:135], v[44:47], v[188:191]
    s_waitcnt lgkmcnt(6)
    v_mfma_f32_16x16x32_bf16 v[136:139], v[80:83], v[48:51], v[136:139]
    ds_read_b128 v[108:111], v254 offset:27648
    v_mfma_f32_16x16x32_bf16 v[164:167], v[80:83], v[52:55], v[164:167]
    buffer_load_dwordx4 v[32:35], v1, s[4:7], s12 offen offset:2048 sc1
    s_waitcnt lgkmcnt(6)
    v_mfma_f32_16x16x32_bf16 v[140:143], v[84:87], v[48:51], v[140:143]
    ds_read_b128 v[112:115], v254 offset:28672
    v_mfma_f32_16x16x32_bf16 v[168:171], v[84:87], v[52:55], v[168:171]
    s_waitcnt lgkmcnt(6)
    v_mfma_f32_16x16x32_bf16 v[144:147], v[88:91], v[48:51], v[144:147]
    ds_read_b128 v[116:119], v254 offset:29696
    v_mfma_f32_16x16x32_bf16 v[172:175], v[88:91], v[52:55], v[172:175]
    s_waitcnt lgkmcnt(6)
    v_mfma_f32_16x16x32_bf16 v[148:151], v[92:95], v[48:51], v[148:151]
    ds_read_b128 v[120:123], v254 offset:30720
    v_mfma_f32_16x16x32_bf16 v[176:179], v[92:95], v[52:55], v[176:179]
    s_waitcnt lgkmcnt(6)
    v_mfma_f32_16x16x32_bf16 v[152:155], v[96:99], v[48:51], v[152:155]
    ds_read_b128 v[124:127], v254 offset:31744
    buffer_load_dwordx4 v[36:39], v1, s[4:7], s13 offen offset:2048 sc1
    v_mfma_f32_16x16x32_bf16 v[180:183], v[96:99], v[52:55], v[180:183]
    s_waitcnt lgkmcnt(6)
    v_mfma_f32_16x16x32_bf16 v[156:159], v[100:103], v[48:51], v[156:159]
    ds_read_b128 v[128:131], v254 offset:32768
    v_mfma_f32_16x16x32_bf16 v[184:187], v[100:103], v[52:55], v[184:187]
    s_waitcnt lgkmcnt(6)
    v_mfma_f32_16x16x32_bf16 v[160:163], v[104:107], v[48:51], v[160:163]
    ds_read_b128 v[132:135], v254 offset:33792
    v_mfma_f32_16x16x32_bf16 v[188:191], v[104:107], v[52:55], v[188:191]
    s_waitcnt vmcnt(6)
    s_waitcnt lgkmcnt(6)
    v_mfma_f32_16x16x32_bf16 v[136:139], v[108:111], v[56:59], v[136:139]
    ds_read_b128 v[80:83], v254 offset:34816
    v_mfma_f32_16x16x32_bf16 v[164:167], v[108:111], v[60:63], v[164:167]
    buffer_load_dwordx4 v[40:43], v1, s[4:7], s12 offen offset:3072 sc1
    s_add_u32 s12, s12, 4096
    s_waitcnt lgkmcnt(6)
    v_mfma_f32_16x16x32_bf16 v[140:143], v[112:115], v[56:59], v[140:143]
    ds_read_b128 v[84:87], v254 offset:35840
    v_mfma_f32_16x16x32_bf16 v[168:171], v[112:115], v[60:63], v[168:171]
    s_waitcnt lgkmcnt(6)
    v_mfma_f32_16x16x32_bf16 v[144:147], v[116:119], v[56:59], v[144:147]
    ds_read_b128 v[88:91], v254 offset:36864
    v_mfma_f32_16x16x32_bf16 v[172:175], v[116:119], v[60:63], v[172:175]
    s_waitcnt lgkmcnt(6)
    v_mfma_f32_16x16x32_bf16 v[148:151], v[120:123], v[56:59], v[148:151]
    ds_read_b128 v[92:95], v254 offset:37888
    v_mfma_f32_16x16x32_bf16 v[176:179], v[120:123], v[60:63], v[176:179]
    s_waitcnt lgkmcnt(6)
    v_mfma_f32_16x16x32_bf16 v[152:155], v[124:127], v[56:59], v[152:155]
    ds_read_b128 v[96:99], v254 offset:38912
    buffer_load_dwordx4 v[44:47], v1, s[4:7], s13 offen offset:3072 sc1
    s_add_u32 s13, s13, 4096
    v_mfma_f32_16x16x32_bf16 v[180:183], v[124:127], v[60:63], v[180:183]
    s_waitcnt lgkmcnt(6)
    v_mfma_f32_16x16x32_bf16 v[156:159], v[128:131], v[56:59], v[156:159]
    ds_read_b128 v[100:103], v254 offset:39936
    v_mfma_f32_16x16x32_bf16 v[184:187], v[128:131], v[60:63], v[184:187]
    s_waitcnt lgkmcnt(6)
    v_mfma_f32_16x16x32_bf16 v[160:163], v[132:135], v[56:59], v[160:163]
    ds_read_b128 v[104:107], v254 offset:40960
    v_mfma_f32_16x16x32_bf16 v[188:191], v[132:135], v[60:63], v[188:191]
    s_waitcnt lgkmcnt(6)
    v_mfma_f32_16x16x32_bf16 v[136:139], v[80:83], v[64:67], v[136:139]
    ds_read_b128 v[108:111], v254 offset:41984
    v_mfma_f32_16x16x32_bf16 v[164:167], v[80:83], v[68:71], v[164:167]
    s_waitcnt lgkmcnt(6)
    v_mfma_f32_16x16x32_bf16 v[140:143], v[84:87], v[64:67], v[140:143]
    ds_read_b128 v[112:115], v254 offset:43008
    v_mfma_f32_16x16x32_bf16 v[168:171], v[84:87], v[68:71], v[168:171]
    s_waitcnt lgkmcnt(6)
    v_mfma_f32_16x16x32_bf16 v[144:147], v[88:91], v[64:67], v[144:147]
    ds_read_b128 v[116:119], v254 offset:44032
    v_mfma_f32_16x16x32_bf16 v[172:175], v[88:91], v[68:71], v[172:175]
    s_waitcnt lgkmcnt(6)
    v_mfma_f32_16x16x32_bf16 v[148:151], v[92:95], v[64:67], v[148:151]
    ds_read_b128 v[120:123], v254 offset:45056
    v_mfma_f32_16x16x32_bf16 v[176:179], v[92:95], v[68:71], v[176:179]
    s_waitcnt lgkmcnt(6)
    v_mfma_f32_16x16x32_bf16 v[152:155], v[96:99], v[64:67], v[152:155]
    ds_read_b128 v[124:127], v254 offset:46080
    v_mfma_f32_16x16x32_bf16 v[180:183], v[96:99], v[68:71], v[180:183]
    s_waitcnt lgkmcnt(6)
    v_mfma_f32_16x16x32_bf16 v[156:159], v[100:103], v[64:67], v[156:159]
    ds_read_b128 v[128:131], v254 offset:47104
    v_mfma_f32_16x16x32_bf16 v[184:187], v[100:103], v[68:71], v[184:187]
    s_waitcnt lgkmcnt(6)
    v_mfma_f32_16x16x32_bf16 v[160:163], v[104:107], v[64:67], v[160:163]
    ds_read_b128 v[132:135], v254 offset:48128
    v_mfma_f32_16x16x32_bf16 v[188:191], v[104:107], v[68:71], v[188:191]
    s_waitcnt vmcnt(4)
    s_waitcnt lgkmcnt(6)
    v_mfma_f32_16x16x32_bf16 v[136:139], v[108:111], v[72:75], v[136:139]
    ds_read_b128 v[80:83], v254 offset:49152
    v_mfma_f32_16x16x32_bf16 v[164:167], v[108:111], v[76:79], v[164:167]
    s_waitcnt lgkmcnt(6)
    v_mfma_f32_16x16x32_bf16 v[140:143], v[112:115], v[72:75], v[140:143]
    ds_read_b128 v[84:87], v254 offset:50176
    v_mfma_f32_16x16x32_bf16 v[168:171], v[112:115], v[76:79], v[168:171]
    s_waitcnt lgkmcnt(6)
    v_mfma_f32_16x16x32_bf16 v[144:147], v[116:119], v[72:75], v[144:147]
    ds_read_b128 v[88:91], v254 offset:51200
    v_mfma_f32_16x16x32_bf16 v[172:175], v[116:119], v[76:79], v[172:175]
    s_waitcnt lgkmcnt(6)
    v_mfma_f32_16x16x32_bf16 v[148:151], v[120:123], v[72:75], v[148:151]
    ds_read_b128 v[92:95], v254 offset:52224
    v_mfma_f32_16x16x32_bf16 v[176:179], v[120:123], v[76:79], v[176:179]
    s_waitcnt lgkmcnt(6)
    v_mfma_f32_16x16x32_bf16 v[152:155], v[124:127], v[72:75], v[152:155]
    ds_read_b128 v[96:99], v254 offset:53248
    v_mfma_f32_16x16x32_bf16 v[180:183], v[124:127], v[76:79], v[180:183]
    s_waitcnt lgkmcnt(6)
    v_mfma_f32_16x16x32_bf16 v[156:159], v[128:131], v[72:75], v[156:159]
    ds_read_b128 v[100:103], v254 offset:54272
    v_mfma_f32_16x16x32_bf16 v[184:187], v[128:131], v[76:79], v[184:187]
    s_waitcnt lgkmcnt(6)
    v_mfma_f32_16x16x32_bf16 v[160:163], v[132:135], v[72:75], v[160:163]
    ds_read_b128 v[104:107], v254 offset:55296
    v_mfma_f32_16x16x32_bf16 v[188:191], v[132:135], v[76:79], v[188:191]
    s_waitcnt lgkmcnt(6)
    v_mfma_f32_16x16x32_bf16 v[136:139], v[80:83], v[16:19], v[136:139]
    ds_read_b128 v[108:111], v254 offset:56320
    v_mfma_f32_16x16x32_bf16 v[164:167], v[80:83], v[20:23], v[164:167]
    s_waitcnt lgkmcnt(6)
    v_mfma_f32_16x16x32_bf16 v[140:143], v[84:87], v[16:19], v[140:143]
    ds_read_b128 v[112:115], v254 offset:57344
    v_mfma_f32_16x16x32_bf16 v[168:171], v[84:87], v[20:23], v[168:171]
    s_waitcnt lgkmcnt(6)
    v_mfma_f32_16x16x32_bf16 v[144:147], v[88:91], v[16:19], v[144:147]
    ds_read_b128 v[116:119], v254 offset:58368
    v_mfma_f32_16x16x32_bf16 v[172:175], v[88:91], v[20:23], v[172:175]
    s_waitcnt lgkmcnt(6)
    v_mfma_f32_16x16x32_bf16 v[148:151], v[92:95], v[16:19], v[148:151]
    ds_read_b128 v[120:123], v254 offset:59392
    v_mfma_f32_16x16x32_bf16 v[176:179], v[92:95], v[20:23], v[176:179]
    s_waitcnt lgkmcnt(6)
    v_mfma_f32_16x16x32_bf16 v[152:155], v[96:99], v[16:19], v[152:155]
    ds_read_b128 v[124:127], v254 offset:60416
    v_mfma_f32_16x16x32_bf16 v[180:183], v[96:99], v[20:23], v[180:183]
    s_waitcnt lgkmcnt(6)
    v_mfma_f32_16x16x32_bf16 v[156:159], v[100:103], v[16:19], v[156:159]
    ds_read_b128 v[128:131], v254 offset:61440
    v_mfma_f32_16x16x32_bf16 v[184:187], v[100:103], v[20:23], v[184:187]
    s_waitcnt lgkmcnt(6)
    v_mfma_f32_16x16x32_bf16 v[160:163], v[104:107], v[16:19], v[160:163]
    ds_read_b128 v[132:135], v254 offset:62464
    v_mfma_f32_16x16x32_bf16 v[188:191], v[104:107], v[20:23], v[188:191]
    s_waitcnt vmcnt(0)
    s_waitcnt lgkmcnt(6)
    v_mfma_f32_16x16x32_bf16 v[136:139], v[108:111], v[24:27], v[136:139]
    ds_read_b128 v[80:83], v254 offset:63488
    v_mfma_f32_16x16x32_bf16 v[164:167], v[108:111], v[28:31], v[164:167]
    s_waitcnt lgkmcnt(6)
    v_mfma_f32_16x16x32_bf16 v[140:143], v[112:115], v[24:27], v[140:143]
    ds_read_b128 v[84:87], v254 offset:64512
    v_mfma_f32_16x16x32_bf16 v[168:171], v[112:115], v[28:31], v[168:171]
    s_waitcnt lgkmcnt(6)
    v_mfma_f32_16x16x32_bf16 v[144:147], v[116:119], v[24:27], v[144:147]
    ds_read_b128 v[88:91], v255 offset:0
    v_mfma_f32_16x16x32_bf16 v[172:175], v[116:119], v[28:31], v[172:175]
    s_waitcnt lgkmcnt(6)
    v_mfma_f32_16x16x32_bf16 v[148:151], v[120:123], v[24:27], v[148:151]
    ds_read_b128 v[92:95], v255 offset:1024
    v_mfma_f32_16x16x32_bf16 v[176:179], v[120:123], v[28:31], v[176:179]
    s_waitcnt lgkmcnt(6)
    v_mfma_f32_16x16x32_bf16 v[152:155], v[124:127], v[24:27], v[152:155]
    ds_read_b128 v[96:99], v255 offset:2048
    v_mfma_f32_16x16x32_bf16 v[180:183], v[124:127], v[28:31], v[180:183]
    s_waitcnt lgkmcnt(6)
    v_mfma_f32_16x16x32_bf16 v[156:159], v[128:131], v[24:27], v[156:159]
    ds_read_b128 v[100:103], v255 offset:3072
    v_mfma_f32_16x16x32_bf16 v[184:187], v[128:131], v[28:31], v[184:187]
    s_waitcnt lgkmcnt(6)
    v_mfma_f32_16x16x32_bf16 v[160:163], v[132:135], v[24:27], v[160:163]
    ds_read_b128 v[104:107], v255 offset:4096
    v_mfma_f32_16x16x32_bf16 v[188:191], v[132:135], v[28:31], v[188:191]
    s_waitcnt lgkmcnt(6)
    v_mfma_f32_16x16x32_bf16 v[136:139], v[80:83], v[32:35], v[136:139]
    ds_read_b128 v[108:111], v255 offset:5120
    v_mfma_f32_16x16x32_bf16 v[164:167], v[80:83], v[36:39], v[164:167]
    s_waitcnt lgkmcnt(6)
    v_mfma_f32_16x16x32_bf16 v[140:143], v[84:87], v[32:35], v[140:143]
    ds_read_b128 v[112:115], v255 offset:6144
    v_mfma_f32_16x16x32_bf16 v[168:171], v[84:87], v[36:39], v[168:171]
    s_waitcnt lgkmcnt(6)
    v_mfma_f32_16x16x32_bf16 v[144:147], v[88:91], v[32:35], v[144:147]
    ds_read_b128 v[116:119], v255 offset:7168
    v_mfma_f32_16x16x32_bf16 v[172:175], v[88:91], v[36:39], v[172:175]
    s_waitcnt lgkmcnt(6)
    v_mfma_f32_16x16x32_bf16 v[148:151], v[92:95], v[32:35], v[148:151]
    ds_read_b128 v[120:123], v255 offset:8192
    v_mfma_f32_16x16x32_bf16 v[176:179], v[92:95], v[36:39], v[176:179]
    s_waitcnt lgkmcnt(6)
    v_mfma_f32_16x16x32_bf16 v[152:155], v[96:99], v[32:35], v[152:155]
    ds_read_b128 v[124:127], v255 offset:9216
    v_mfma_f32_16x16x32_bf16 v[180:183], v[96:99], v[36:39], v[180:183]
    s_waitcnt lgkmcnt(6)
    v_mfma_f32_16x16x32_bf16 v[156:159], v[100:103], v[32:35], v[156:159]
    ds_read_b128 v[128:131], v255 offset:10240
    v_mfma_f32_16x16x32_bf16 v[184:187], v[100:103], v[36:39], v[184:187]
    s_waitcnt lgkmcnt(6)
    v_mfma_f32_16x16x32_bf16 v[160:163], v[104:107], v[32:35], v[160:163]
    ds_read_b128 v[132:135], v255 offset:11264
    v_mfma_f32_16x16x32_bf16 v[188:191], v[104:107], v[36:39], v[188:191]
    s_waitcnt lgkmcnt(6)
    v_mfma_f32_16x16x32_bf16 v[136:139], v[108:111], v[40:43], v[136:139]
    v_mfma_f32_16x16x32_bf16 v[164:167], v[108:111], v[44:47], v[164:167]
    s_waitcnt lgkmcnt(5)
    v_mfma_f32_16x16x32_bf16 v[140:143], v[112:115], v[40:43], v[140:143]
    v_mfma_f32_16x16x32_bf16 v[168:171], v[112:115], v[44:47], v[168:171]
    s_waitcnt lgkmcnt(4)
    v_mfma_f32_16x16x32_bf16 v[144:147], v[116:119], v[40:43], v[144:147]
    v_mfma_f32_16x16x32_bf16 v[172:175], v[116:119], v[44:47], v[172:175]
    s_waitcnt lgkmcnt(3)
    v_mfma_f32_16x16x32_bf16 v[148:151], v[120:123], v[40:43], v[148:151]
    v_mfma_f32_16x16x32_bf16 v[176:179], v[120:123], v[44:47], v[176:179]
    s_waitcnt lgkmcnt(2)
    v_mfma_f32_16x16x32_bf16 v[152:155], v[124:127], v[40:43], v[152:155]
    v_mfma_f32_16x16x32_bf16 v[180:183], v[124:127], v[44:47], v[180:183]
    s_waitcnt lgkmcnt(1)
    v_mfma_f32_16x16x32_bf16 v[156:159], v[128:131], v[40:43], v[156:159]
    v_mfma_f32_16x16x32_bf16 v[184:187], v[128:131], v[44:47], v[184:187]
    s_waitcnt lgkmcnt(0)
    v_mfma_f32_16x16x32_bf16 v[160:163], v[132:135], v[40:43], v[160:163]
    v_mfma_f32_16x16x32_bf16 v[188:191], v[132:135], v[44:47], v[188:191]
    ds_read_b128 v[16:19], v7 offset:0
    ds_read_b128 v[20:23], v7 offset:512
    ds_read_b128 v[24:27], v7 offset:64
    ds_read_b128 v[28:31], v7 offset:576
    ds_read_b128 v[32:35], v7 offset:128
    ds_read_b128 v[36:39], v7 offset:640
    ds_read_b128 v[40:43], v7 offset:192
    ds_read_b128 v[44:47], v7 offset:704
    ds_read_b128 v[48:51], v7 offset:256
    ds_read_b128 v[52:55], v7 offset:768
    ds_read_b128 v[56:59], v7 offset:320
    ds_read_b128 v[60:63], v7 offset:832
    ds_read_b128 v[64:67], v7 offset:384
    ds_read_b128 v[68:71], v7 offset:896
    s_mov_b32 s20, 0xc0135761
    s_mov_b32 s21, 0xc0135761
    s_mov_b32 s22, 0xbdd2d3e8
    s_mov_b32 s23, 0xbdd2d3e8
    s_mul_i32 s17, s16, 57344
    s_mul_i32 s18, s27, 1792
    s_add_u32 s17, s17, s18
    s_add_u32 s17, s17, 24641536
    s_add_u32 s18, s17, 57344
    v_pk_add_f32 v[8:9], v[8:9], v[10:11]
    v_pk_add_f32 v[12:13], v[12:13], v[14:15]
    v_mov_b32 v10, v8
    v_mov_b32 v11, v9
    v_mov_b32 v14, v12
    v_mov_b32 v15, v13
    v_permlane16_swap_b32 v8, v10
    v_permlane16_swap_b32 v9, v11
    v_permlane16_swap_b32 v12, v14
    v_permlane16_swap_b32 v13, v15
    v_pk_add_f32 v[8:9], v[8:9], v[10:11]
    v_pk_add_f32 v[12:13], v[12:13], v[14:15]
    v_mov_b32 v10, v8
    v_mov_b32 v11, v9
    v_mov_b32 v14, v12
    v_mov_b32 v15, v13
    v_permlane32_swap_b32 v8, v10
    v_permlane32_swap_b32 v9, v11
    v_permlane32_swap_b32 v12, v14
    v_permlane32_swap_b32 v13, v15
    v_pk_add_f32 v[8:9], v[8:9], v[10:11]
    v_pk_add_f32 v[12:13], v[12:13], v[14:15]
    v_mul_f32 v8, 0x3acccccd, v8
    v_mul_f32 v12, 0x3acccccd, v12
    v_mul_f32 v9, 0x3acccccd, v9
    v_mul_f32 v13, 0x3acccccd, v13
    v_fma_f32 v9, -v8, v8, v9
    v_fma_f32 v13, -v12, v12, v13
    v_max_f32 v9, 0, v9
    v_max_f32 v13, 0, v13
    v_add_f32 v9, 0x3727c5ac, v9
    v_add_f32 v13, 0x3727c5ac, v13
    v_rsq_f32 v9, v9
    v_rsq_f32 v13, v13
    v_mul_f32 v8, v8, v9
    v_mul_f32 v12, v12, v13
    s_waitcnt lgkmcnt(0)
    v_pk_fma_f32 v[80:81], v[8:9], v[16:17], v[20:21] op_sel_hi:[0,1,1] neg_lo:[1,0,0] neg_hi:[1,0,0]
    v_pk_fma_f32 v[82:83], v[8:9], v[18:19], v[22:23] op_sel_hi:[0,1,1] neg_lo:[1,0,0] neg_hi:[1,0,0]
    v_pk_fma_f32 v[84:85], v[8:9], v[24:25], v[28:29] op_sel_hi:[0,1,1] neg_lo:[1,0,0] neg_hi:[1,0,0]
    v_pk_fma_f32 v[86:87], v[8:9], v[26:27], v[30:31] op_sel_hi:[0,1,1] neg_lo:[1,0,0] neg_hi:[1,0,0]
    v_pk_fma_f32 v[88:89], v[8:9], v[32:33], v[36:37] op_sel_hi:[0,1,1] neg_lo:[1,0,0] neg_hi:[1,0,0]
    v_pk_fma_f32 v[90:91], v[8:9], v[34:35], v[38:39] op_sel_hi:[0,1,1] neg_lo:[1,0,0] neg_hi:[1,0,0]
    v_pk_fma_f32 v[92:93], v[8:9], v[40:41], v[44:45] op_sel_hi:[0,1,1] neg_lo:[1,0,0] neg_hi:[1,0,0]
    v_pk_fma_f32 v[94:95], v[8:9], v[42:43], v[46:47] op_sel_hi:[0,1,1] neg_lo:[1,0,0] neg_hi:[1,0,0]
    v_pk_fma_f32 v[96:97], v[8:9], v[48:49], v[52:53] op_sel_hi:[0,1,1] neg_lo:[1,0,0] neg_hi:[1,0,0]
    v_pk_fma_f32 v[98:99], v[8:9], v[50:51], v[54:55] op_sel_hi:[0,1,1] neg_lo:[1,0,0] neg_hi:[1,0,0]
    v_pk_fma_f32 v[100:101], v[8:9], v[56:57], v[60:61] op_sel_hi:[0,1,1] neg_lo:[1,0,0] neg_hi:[1,0,0]
    v_pk_fma_f32 v[102:103], v[8:9], v[58:59], v[62:63] op_sel_hi:[0,1,1] neg_lo:[1,0,0] neg_hi:[1,0,0]
    v_pk_fma_f32 v[104:105], v[8:9], v[64:65], v[68:69] op_sel_hi:[0,1,1] neg_lo:[1,0,0] neg_hi:[1,0,0]
    v_pk_fma_f32 v[106:107], v[8:9], v[66:67], v[70:71] op_sel_hi:[0,1,1] neg_lo:[1,0,0] neg_hi:[1,0,0]
    v_pk_fma_f32 v[80:81], v[8:9], v[136:137], v[80:81] op_sel:[1,0,0] op_sel_hi:[1,1,1]
    v_pk_fma_f32 v[82:83], v[8:9], v[138:139], v[82:83] op_sel:[1,0,0] op_sel_hi:[1,1,1]
    v_pk_fma_f32 v[84:85], v[8:9], v[140:141], v[84:85] op_sel:[1,0,0] op_sel_hi:[1,1,1]
    v_pk_fma_f32 v[86:87], v[8:9], v[142:143], v[86:87] op_sel:[1,0,0] op_sel_hi:[1,1,1]
    v_pk_fma_f32 v[88:89], v[8:9], v[144:145], v[88:89] op_sel:[1,0,0] op_sel_hi:[1,1,1]
    v_pk_fma_f32 v[90:91], v[8:9], v[146:147], v[90:91] op_sel:[1,0,0] op_sel_hi:[1,1,1]
    v_pk_fma_f32 v[92:93], v[8:9], v[148:149], v[92:93] op_sel:[1,0,0] op_sel_hi:[1,1,1]
    v_pk_fma_f32 v[94:95], v[8:9], v[150:151], v[94:95] op_sel:[1,0,0] op_sel_hi:[1,1,1]
    v_pk_fma_f32 v[96:97], v[8:9], v[152:153], v[96:97] op_sel:[1,0,0] op_sel_hi:[1,1,1]
    v_pk_fma_f32 v[98:99], v[8:9], v[154:155], v[98:99] op_sel:[1,0,0] op_sel_hi:[1,1,1]
    v_pk_fma_f32 v[100:101], v[8:9], v[156:157], v[100:101] op_sel:[1,0,0] op_sel_hi:[1,1,1]
    v_pk_fma_f32 v[102:103], v[8:9], v[158:159], v[102:103] op_sel:[1,0,0] op_sel_hi:[1,1,1]
    v_pk_fma_f32 v[104:105], v[8:9], v[160:161], v[104:105] op_sel:[1,0,0] op_sel_hi:[1,1,1]
    v_pk_fma_f32 v[106:107], v[8:9], v[162:163], v[106:107] op_sel:[1,0,0] op_sel_hi:[1,1,1]
    v_pk_mul_f32 v[108:109], v[80:81], v[80:81]
    v_pk_mul_f32 v[110:111], v[84:85], v[84:85]
    v_pk_mul_f32 v[112:113], v[88:89], v[88:89]
    v_pk_mul_f32 v[114:115], v[92:93], v[92:93]
    v_pk_mul_f32 v[116:117], v[96:97], v[96:97]
    v_pk_mul_f32 v[118:119], v[100:101], v[100:101]
    v_pk_mul_f32 v[120:121], v[104:105], v[104:105]
    v_pk_mul_f32 v[108:109], v[108:109], s[22:23]
    v_pk_mul_f32 v[110:111], v[110:111], s[22:23]
    v_pk_mul_f32 v[112:113], v[112:113], s[22:23]
    v_pk_mul_f32 v[114:115], v[114:115], s[22:23]
    v_pk_mul_f32 v[116:117], v[116:117], s[22:23]
    v_pk_mul_f32 v[118:119], v[118:119], s[22:23]
    v_pk_mul_f32 v[120:121], v[120:121], s[22:23]
    v_pk_add_f32 v[108:109], v[108:109], s[20:21]
    v_pk_add_f32 v[110:111], v[110:111], s[20:21]
    v_pk_add_f32 v[112:113], v[112:113], s[20:21]
    v_pk_add_f32 v[114:115], v[114:115], s[20:21]
    v_pk_add_f32 v[116:117], v[116:117], s[20:21]
    v_pk_add_f32 v[118:119], v[118:119], s[20:21]
    v_pk_add_f32 v[120:121], v[120:121], s[20:21]
    v_pk_mul_f32 v[108:109], v[108:109], v[80:81]
    v_pk_mul_f32 v[110:111], v[110:111], v[84:85]
    v_pk_mul_f32 v[112:113], v[112:113], v[88:89]
    v_pk_mul_f32 v[114:115], v[114:115], v[92:93]
    v_pk_mul_f32 v[116:117], v[116:117], v[96:97]
    v_pk_mul_f32 v[118:119], v[118:119], v[100:101]
    v_pk_mul_f32 v[120:121], v[120:121], v[104:105]
    v_exp_f32 v108, v108
    v_exp_f32 v109, v109
    v_exp_f32 v110, v110
    v_exp_f32 v111, v111
    v_exp_f32 v112, v112
    v_exp_f32 v113, v113
    v_exp_f32 v114, v114
    v_exp_f32 v115, v115
    v_exp_f32 v116, v116
    v_exp_f32 v117, v117
    v_exp_f32 v118, v118
    v_exp_f32 v119, v119
    v_exp_f32 v120, v120
    v_exp_f32 v121, v121
    v_pk_mul_f32 v[80:81], v[80:81], v[82:83]
    v_pk_mul_f32 v[84:85], v[84:85], v[86:87]
    v_pk_mul_f32 v[88:89], v[88:89], v[90:91]
    v_pk_mul_f32 v[92:93], v[92:93], v[94:95]
    v_pk_mul_f32 v[96:97], v[96:97], v[98:99]
    v_pk_mul_f32 v[100:101], v[100:101], v[102:103]
    v_pk_mul_f32 v[104:105], v[104:105], v[106:107]
    v_pk_add_f32 v[108:109], v[108:109], 1.0 op_sel_hi:[1,0]
    v_pk_add_f32 v[110:111], v[110:111], 1.0 op_sel_hi:[1,0]
    v_pk_add_f32 v[112:113], v[112:113], 1.0 op_sel_hi:[1,0]
    v_pk_add_f32 v[114:115], v[114:115], 1.0 op_sel_hi:[1,0]
    v_pk_add_f32 v[116:117], v[116:117], 1.0 op_sel_hi:[1,0]
    v_pk_add_f32 v[118:119], v[118:119], 1.0 op_sel_hi:[1,0]
    v_pk_add_f32 v[120:121], v[120:121], 1.0 op_sel_hi:[1,0]
    v_rcp_f32 v108, v108
    v_rcp_f32 v109, v109
    v_rcp_f32 v110, v110
    v_rcp_f32 v111, v111
    v_rcp_f32 v112, v112
    v_rcp_f32 v113, v113
    v_rcp_f32 v114, v114
    v_rcp_f32 v115, v115
    v_rcp_f32 v116, v116
    v_rcp_f32 v117, v117
    v_rcp_f32 v118, v118
    v_rcp_f32 v119, v119
    v_rcp_f32 v120, v120
    v_rcp_f32 v121, v121
    v_pk_mul_f32 v[80:81], v[80:81], v[108:109]
    v_pk_mul_f32 v[84:85], v[84:85], v[110:111]
    v_pk_mul_f32 v[88:89], v[88:89], v[112:113]
    v_pk_mul_f32 v[92:93], v[92:93], v[114:115]
    v_pk_mul_f32 v[96:97], v[96:97], v[116:117]
    v_pk_mul_f32 v[100:101], v[100:101], v[118:119]
    v_pk_mul_f32 v[104:105], v[104:105], v[120:121]
    v_cvt_pk_bf16_f32 v124, v80, v81
    v_cvt_pk_bf16_f32 v125, v84, v85
    v_cvt_pk_bf16_f32 v126, v88, v89
    v_cvt_pk_bf16_f32 v127, v92, v93
    v_cvt_pk_bf16_f32 v128, v96, v97
    v_cvt_pk_bf16_f32 v129, v100, v101
    v_cvt_pk_bf16_f32 v130, v104, v105
    buffer_store_dwordx4 v[124:127], v1, s[4:7], s17 offen sc1
    buffer_store_dword v128, v249, s[4:7], s17 offen offset:1024 sc1
    buffer_store_dword v129, v249, s[4:7], s17 offen offset:1280 sc1
    buffer_store_dword v130, v249, s[4:7], s17 offen offset:1536 sc1
    v_pk_fma_f32 v[80:81], v[12:13], v[16:17], v[20:21] op_sel_hi:[0,1,1] neg_lo:[1,0,0] neg_hi:[1,0,0]
    v_pk_fma_f32 v[82:83], v[12:13], v[18:19], v[22:23] op_sel_hi:[0,1,1] neg_lo:[1,0,0] neg_hi:[1,0,0]
    v_pk_fma_f32 v[84:85], v[12:13], v[24:25], v[28:29] op_sel_hi:[0,1,1] neg_lo:[1,0,0] neg_hi:[1,0,0]
    v_pk_fma_f32 v[86:87], v[12:13], v[26:27], v[30:31] op_sel_hi:[0,1,1] neg_lo:[1,0,0] neg_hi:[1,0,0]
    v_pk_fma_f32 v[88:89], v[12:13], v[32:33], v[36:37] op_sel_hi:[0,1,1] neg_lo:[1,0,0] neg_hi:[1,0,0]
    v_pk_fma_f32 v[90:91], v[12:13], v[34:35], v[38:39] op_sel_hi:[0,1,1] neg_lo:[1,0,0] neg_hi:[1,0,0]
    v_pk_fma_f32 v[92:93], v[12:13], v[40:41], v[44:45] op_sel_hi:[0,1,1] neg_lo:[1,0,0] neg_hi:[1,0,0]
    v_pk_fma_f32 v[94:95], v[12:13], v[42:43], v[46:47] op_sel_hi:[0,1,1] neg_lo:[1,0,0] neg_hi:[1,0,0]
    v_pk_fma_f32 v[96:97], v[12:13], v[48:49], v[52:53] op_sel_hi:[0,1,1] neg_lo:[1,0,0] neg_hi:[1,0,0]
    v_pk_fma_f32 v[98:99], v[12:13], v[50:51], v[54:55] op_sel_hi:[0,1,1] neg_lo:[1,0,0] neg_hi:[1,0,0]
    v_pk_fma_f32 v[100:101], v[12:13], v[56:57], v[60:61] op_sel_hi:[0,1,1] neg_lo:[1,0,0] neg_hi:[1,0,0]
    v_pk_fma_f32 v[102:103], v[12:13], v[58:59], v[62:63] op_sel_hi:[0,1,1] neg_lo:[1,0,0] neg_hi:[1,0,0]
    v_pk_fma_f32 v[104:105], v[12:13], v[64:65], v[68:69] op_sel_hi:[0,1,1] neg_lo:[1,0,0] neg_hi:[1,0,0]
    v_pk_fma_f32 v[106:107], v[12:13], v[66:67], v[70:71] op_sel_hi:[0,1,1] neg_lo:[1,0,0] neg_hi:[1,0,0]
    v_pk_fma_f32 v[80:81], v[12:13], v[164:165], v[80:81] op_sel:[1,0,0] op_sel_hi:[1,1,1]
    v_pk_fma_f32 v[82:83], v[12:13], v[166:167], v[82:83] op_sel:[1,0,0] op_sel_hi:[1,1,1]
    v_pk_fma_f32 v[84:85], v[12:13], v[168:169], v[84:85] op_sel:[1,0,0] op_sel_hi:[1,1,1]
    v_pk_fma_f32 v[86:87], v[12:13], v[170:171], v[86:87] op_sel:[1,0,0] op_sel_hi:[1,1,1]
    v_pk_fma_f32 v[88:89], v[12:13], v[172:173], v[88:89] op_sel:[1,0,0] op_sel_hi:[1,1,1]
    v_pk_fma_f32 v[90:91], v[12:13], v[174:175], v[90:91] op_sel:[1,0,0] op_sel_hi:[1,1,1]
    v_pk_fma_f32 v[92:93], v[12:13], v[176:177], v[92:93] op_sel:[1,0,0] op_sel_hi:[1,1,1]
    v_pk_fma_f32 v[94:95], v[12:13], v[178:179], v[94:95] op_sel:[1,0,0] op_sel_hi:[1,1,1]
    v_pk_fma_f32 v[96:97], v[12:13], v[180:181], v[96:97] op_sel:[1,0,0] op_sel_hi:[1,1,1]
    v_pk_fma_f32 v[98:99], v[12:13], v[182:183], v[98:99] op_sel:[1,0,0] op_sel_hi:[1,1,1]
    v_pk_fma_f32 v[100:101], v[12:13], v[184:185], v[100:101] op_sel:[1,0,0] op_sel_hi:[1,1,1]
    v_pk_fma_f32 v[102:103], v[12:13], v[186:187], v[102:103] op_sel:[1,0,0] op_sel_hi:[1,1,1]
    v_pk_fma_f32 v[104:105], v[12:13], v[188:189], v[104:105] op_sel:[1,0,0] op_sel_hi:[1,1,1]
    v_pk_fma_f32 v[106:107], v[12:13], v[190:191], v[106:107] op_sel:[1,0,0] op_sel_hi:[1,1,1]
    v_pk_mul_f32 v[108:109], v[80:81], v[80:81]
    v_pk_mul_f32 v[110:111], v[84:85], v[84:85]
    v_pk_mul_f32 v[112:113], v[88:89], v[88:89]
    v_pk_mul_f32 v[114:115], v[92:93], v[92:93]
    v_pk_mul_f32 v[116:117], v[96:97], v[96:97]
    v_pk_mul_f32 v[118:119], v[100:101], v[100:101]
    v_pk_mul_f32 v[120:121], v[104:105], v[104:105]
    v_pk_mul_f32 v[108:109], v[108:109], s[22:23]
    v_pk_mul_f32 v[110:111], v[110:111], s[22:23]
    v_pk_mul_f32 v[112:113], v[112:113], s[22:23]
    v_pk_mul_f32 v[114:115], v[114:115], s[22:23]
    v_pk_mul_f32 v[116:117], v[116:117], s[22:23]
    v_pk_mul_f32 v[118:119], v[118:119], s[22:23]
    v_pk_mul_f32 v[120:121], v[120:121], s[22:23]
    v_pk_add_f32 v[108:109], v[108:109], s[20:21]
    v_pk_add_f32 v[110:111], v[110:111], s[20:21]
    v_pk_add_f32 v[112:113], v[112:113], s[20:21]
    v_pk_add_f32 v[114:115], v[114:115], s[20:21]
    v_pk_add_f32 v[116:117], v[116:117], s[20:21]
    v_pk_add_f32 v[118:119], v[118:119], s[20:21]
    v_pk_add_f32 v[120:121], v[120:121], s[20:21]
    v_pk_mul_f32 v[108:109], v[108:109], v[80:81]
    v_pk_mul_f32 v[110:111], v[110:111], v[84:85]
    v_pk_mul_f32 v[112:113], v[112:113], v[88:89]
    v_pk_mul_f32 v[114:115], v[114:115], v[92:93]
    v_pk_mul_f32 v[116:117], v[116:117], v[96:97]
    v_pk_mul_f32 v[118:119], v[118:119], v[100:101]
    v_pk_mul_f32 v[120:121], v[120:121], v[104:105]
    v_exp_f32 v108, v108
    v_exp_f32 v109, v109
    v_exp_f32 v110, v110
    v_exp_f32 v111, v111
    v_exp_f32 v112, v112
    v_exp_f32 v113, v113
    v_exp_f32 v114, v114
    v_exp_f32 v115, v115
    v_exp_f32 v116, v116
    v_exp_f32 v117, v117
    v_exp_f32 v118, v118
    v_exp_f32 v119, v119
    v_exp_f32 v120, v120
    v_exp_f32 v121, v121
    v_pk_mul_f32 v[80:81], v[80:81], v[82:83]
    v_pk_mul_f32 v[84:85], v[84:85], v[86:87]
    v_pk_mul_f32 v[88:89], v[88:89], v[90:91]
    v_pk_mul_f32 v[92:93], v[92:93], v[94:95]
    v_pk_mul_f32 v[96:97], v[96:97], v[98:99]
    v_pk_mul_f32 v[100:101], v[100:101], v[102:103]
    v_pk_mul_f32 v[104:105], v[104:105], v[106:107]
    v_pk_add_f32 v[108:109], v[108:109], 1.0 op_sel_hi:[1,0]
    v_pk_add_f32 v[110:111], v[110:111], 1.0 op_sel_hi:[1,0]
    v_pk_add_f32 v[112:113], v[112:113], 1.0 op_sel_hi:[1,0]
    v_pk_add_f32 v[114:115], v[114:115], 1.0 op_sel_hi:[1,0]
    v_pk_add_f32 v[116:117], v[116:117], 1.0 op_sel_hi:[1,0]
    v_pk_add_f32 v[118:119], v[118:119], 1.0 op_sel_hi:[1,0]
    v_pk_add_f32 v[120:121], v[120:121], 1.0 op_sel_hi:[1,0]
    v_rcp_f32 v108, v108
    v_rcp_f32 v109, v109
    v_rcp_f32 v110, v110
    v_rcp_f32 v111, v111
    v_rcp_f32 v112, v112
    v_rcp_f32 v113, v113
    v_rcp_f32 v114, v114
    v_rcp_f32 v115, v115
    v_rcp_f32 v116, v116
    v_rcp_f32 v117, v117
    v_rcp_f32 v118, v118
    v_rcp_f32 v119, v119
    v_rcp_f32 v120, v120
    v_rcp_f32 v121, v121
    v_pk_mul_f32 v[80:81], v[80:81], v[108:109]
    v_pk_mul_f32 v[84:85], v[84:85], v[110:111]
    v_pk_mul_f32 v[88:89], v[88:89], v[112:113]
    v_pk_mul_f32 v[92:93], v[92:93], v[114:115]
    v_pk_mul_f32 v[96:97], v[96:97], v[116:117]
    v_pk_mul_f32 v[100:101], v[100:101], v[118:119]
    v_pk_mul_f32 v[104:105], v[104:105], v[120:121]
    v_cvt_pk_bf16_f32 v124, v80, v81
    v_cvt_pk_bf16_f32 v125, v84, v85
    v_cvt_pk_bf16_f32 v126, v88, v89
    v_cvt_pk_bf16_f32 v127, v92, v93
    v_cvt_pk_bf16_f32 v128, v96, v97
    v_cvt_pk_bf16_f32 v129, v100, v101
    v_cvt_pk_bf16_f32 v130, v104, v105
    buffer_store_dwordx4 v[124:127], v1, s[4:7], s18 offen sc1
    buffer_store_dword v128, v249, s[4:7], s18 offen offset:1024 sc1
    buffer_store_dword v129, v249, s[4:7], s18 offen offset:1280 sc1
    buffer_store_dword v130, v249, s[4:7], s18 offen offset:1536 sc1
    s_lshl_b32 s17, s26, 7
    s_lshl_b32 s18, s27, 2
    s_add_u32 s17, s17, s18
    s_add_u32 s17, s17, 398336
    s_waitcnt vmcnt(0)
    s_barrier
    s_cmp_lg_u32 s8, 7
    s_cbranch_scc1 Lsf_21
    v_mov_b32 v2, 1
    v_mov_b32 v3, 0
    s_mov_b64 exec, 1
    buffer_store_dword v2, v3, s[4:7], s17 offen sc1
    s_mov_b64 exec, -1
Lsf_21:
L4_skip:
    s_mov_b32 s56, 0
L4_done:
    s_mul_i32 s15, s25, 276480
    s_add_u32 s15, s15, s9
    s_add_u32 s15, s15, 31981568
    s_add_u32 s14, s15, 122880
    s_cmp_eq_u32 s8, 7
    s_cbranch_scc1 Ld7_22
    s_add_u32 m0, s9, 0
    s_nop 0
    buffer_load_dwordx4 v1, s[4:7], s15 offen sc1 lds
    s_add_u32 s15, s15, 7168
    s_add_u32 m0, s9, 7168
    s_nop 0
    buffer_load_dwordx4 v1, s[4:7], s15 offen sc1 lds
    s_add_u32 s15, s15, 7168
    s_add_u32 m0, s9, 14336
    s_nop 0
    buffer_load_dwordx4 v1, s[4:7], s15 offen sc1 lds
    s_add_u32 s15, s15, 7168
    s_add_u32 m0, s9, 21504
    s_nop 0
    buffer_load_dwordx4 v1, s[4:7], s15 offen sc1 lds
    s_add_u32 s15, s15, 7168
    s_add_u32 m0, s9, 28672
    s_nop 0
    buffer_load_dwordx4 v1, s[4:7], s15 offen sc1 lds
    s_add_u32 s15, s15, 7168
    s_add_u32 m0, s9, 35840
    s_nop 0
    buffer_load_dwordx4 v1, s[4:7], s15 offen sc1 lds
    s_add_u32 s15, s15, 7168
    s_add_u32 m0, s9, 43008
    s_nop 0
    buffer_load_dwordx4 v1, s[4:7], s15 offen sc1 lds
    s_add_u32 s15, s15, 7168
    s_add_u32 m0, s9, 50176
    s_nop 0
    buffer_load_dwordx4 v1, s[4:7], s15 offen sc1 lds
    s_add_u32 s15, s15, 7168
    s_add_u32 m0, s9, 57344
    s_nop 0
    buffer_load_dwordx4 v1, s[4:7], s15 offen sc1 lds
    s_add_u32 s15, s15, 7168
    s_add_u32 m0, s9, 64512
    s_nop 0
    buffer_load_dwordx4 v1, s[4:7], s15 offen sc1 lds
    s_add_u32 s15, s15, 7168
    s_add_u32 m0, s9, 71680
    s_nop 0
    buffer_load_dwordx4 v1, s[4:7], s15 offen sc1 lds
    s_add_u32 s15, s15, 7168
    s_add_u32 m0, s9, 78848
    s_nop 0
    buffer_load_dwordx4 v1, s[4:7], s15 offen sc1 lds
    s_add_u32 s15, s15, 7168
    s_add_u32 m0, s9, 86016
    s_nop 0
    buffer_load_dwordx4 v1, s[4:7], s15 offen sc1 lds
    s_add_u32 s15, s15, 7168
    s_add_u32 m0, s9, 93184
    s_nop 0
    buffer_load_dwordx4 v1, s[4:7], s15 offen sc1 lds
    s_add_u32 s15, s15, 7168
    s_add_u32 m0, s9, 100352
    s_nop 0
    buffer_load_dwordx4 v1, s[4:7], s15 offen sc1 lds
    s_add_u32 s15, s15, 7168
    s_add_u32 m0, s9, 107520
    s_nop 0
    buffer_load_dwordx4 v1, s[4:7], s15 offen sc1 lds
    s_add_u32 s15, s15, 7168
    s_add_u32 m0, s9, 114688
    s_nop 0
    buffer_load_dwordx4 v1, s[4:7], s15 offen sc1 lds
    s_add_u32 s15, s15, 7168
    s_cmp_ge_u32 s8, 1
    s_cbranch_scc1 Ld7_22
    s_add_u32 m0, s9, 121856
    s_nop 0
    buffer_load_dwordx4 v1, s[4:7], s15 offen sc1 lds
    s_add_u32 s15, s15, 7168
Ld7_22:
    s_mul_i32 s12, s30, 57344
    s_mul_i32 s17, s52, 27648
    s_add_u32 s12, s12, s17
    s_add_u32 s12, s12, 24641536
    s_cmp_eq_u32 s52, 1
    s_cbranch_scc1 L5_nox
    s_mul_i32 s17, s25, 2560
    s_add_u32 s17, s17, s31
    s_add_u32 s17, s17, 17301504
    buffer_load_dwordx4 v[8:11], v1, s[4:7], s17 offen sc1
    buffer_load_dwordx4 v[12:15], v1, s[4:7], s17 offen offset:1024 sc1
    buffer_load_dwordx2 v[16:17], v248, s[4:7], s17 offen offset:2048 sc1
L5_nox:
    s_lshr_b32 s17, s24, 2
    s_lshl_b32 s17, s17, 7
    s_add_u32 s17, s17, 398336
    s_mul_i32 s18, s24, 229376
    s_add_u32 s18, s18, 24641536
    s_cmp_lg_u32 s8, 7
    s_cbranch_scc1 Lpw_23
    v_lshlrev_b32 v3, 2, v0
    s_mov_b32 exec_lo, 0x7fffffff
    s_mov_b32 exec_hi, 0x0
    s_mov_b32 s58, 0
Lpl_24:
    buffer_load_dword v2, v3, s[4:7], s17 offen sc1
    s_add_u32 s58, s58, 1
    s_waitcnt vmcnt(0)
    v_cmp_eq_u32 vcc, 1, v2
    s_cmp_gt_u32 s58, 400000
    s_nop 3
    s_cbranch_scc1 Lpe_25
    s_cmp_eq_u64 vcc, exec
    s_cbranch_scc0 Lpl_24
Lpe_25:
    s_mov_b64 exec, -1
Lpw_23:
    s_barrier
    buffer_load_dwordx4 v[48:51], v1, s[4:7], s12 offen offset:0 sc1
    buffer_load_dwordx4 v[52:55], v1, s[4:7], s12 offen offset:1024 sc1
    buffer_load_dwordx4 v[56:59], v1, s[4:7], s12 offen offset:2048 sc1
    buffer_load_dwordx4 v[60:63], v1, s[4:7], s12 offen offset:3072 sc1
    s_add_u32 s12, s12, 4096
    buffer_load_dwordx4 v[64:67], v1, s[4:7], s12 offen offset:0 sc1
    buffer_load_dwordx4 v[68:71], v1, s[4:7], s12 offen offset:1024 sc1
    s_waitcnt vmcnt(5) lgkmcnt(0)
    s_barrier
    ds_read_b128 v[88:91], v251 offset:0
    ds_read_b128 v[92:95], v251 offset:1024
    ds_read_b128 v[96:99], v251 offset:2048
    ds_read_b128 v[100:103], v251 offset:3072
    ds_read_b128 v[104:107], v251 offset:4096
    s_waitcnt vmcnt(4)
    s_barrier
    ds_read_b128 v[108:111], v251 offset:10240
    ds_read_b128 v[112:115], v251 offset:11264
    ds_read_b128 v[116:119], v251 offset:12288
    ds_read_b128 v[120:123], v251 offset:13312
    ds_read_b128 v[124:127], v251 offset:14336
    s_waitcnt vmcnt(3)
    s_barrier
    s_waitcnt lgkmcnt(9)
    v_mfma_f32_16x16x32_bf16 v[148:151], v[88:91], v[48:51], 0
    ds_read_b128 v[128:131], v251 offset:20480
    buffer_load_dwordx4 v[72:75], v1, s[4:7], s12 offen offset:2048 sc1
    s_waitcnt lgkmcnt(9)
    v_mfma_f32_16x16x32_bf16 v[152:155], v[92:95], v[48:51], 0
    ds_read_b128 v[132:135], v251 offset:21504
    s_waitcnt lgkmcnt(9)
    v_mfma_f32_16x16x32_bf16 v[156:159], v[96:99], v[48:51], 0
    ds_read_b128 v[136:139], v251 offset:22528
    buffer_load_dwordx4 v[76:79], v1, s[4:7], s12 offen offset:3072 sc1
    s_add_u32 s12, s12, 4096
    s_waitcnt lgkmcnt(9)
    v_mfma_f32_16x16x32_bf16 v[160:163], v[100:103], v[48:51], 0
    ds_read_b128 v[140:143], v251 offset:23552
    s_waitcnt lgkmcnt(9)
    v_mfma_f32_16x16x32_bf16 v[164:167], v[104:107], v[48:51], 0
    ds_read_b128 v[144:147], v251 offset:24576
    s_waitcnt vmcnt(4)
    s_barrier
    s_waitcnt lgkmcnt(9)
    v_mfma_f32_16x16x32_bf16 v[148:151], v[108:111], v[52:55], v[148:151]
    ds_read_b128 v[88:91], v251 offset:30720
    s_add_u32 m0, s9, 0
    s_nop 0
    buffer_load_dwordx4 v1, s[4:7], s14 offen sc1 lds
    s_add_u32 s14, s14, 8192
    s_waitcnt lgkmcnt(9)
    v_mfma_f32_16x16x32_bf16 v[152:155], v[112:115], v[52:55], v[152:155]
    ds_read_b128 v[92:95], v251 offset:31744
    buffer_load_dwordx4 v[80:83], v1, s[4:7], s12 offen offset:0 sc1
    s_waitcnt lgkmcnt(9)
    v_mfma_f32_16x16x32_bf16 v[156:159], v[116:119], v[52:55], v[156:159]
    ds_read_b128 v[96:99], v251 offset:32768
    s_waitcnt lgkmcnt(9)
    v_mfma_f32_16x16x32_bf16 v[160:163], v[120:123], v[52:55], v[160:163]
    ds_read_b128 v[100:103], v251 offset:33792
    buffer_load_dwordx4 v[84:87], v1, s[4:7], s12 offen offset:1024 sc1
    s_waitcnt lgkmcnt(9)
    v_mfma_f32_16x16x32_bf16 v[164:167], v[124:127], v[52:55], v[164:167]
    ds_read_b128 v[104:107], v251 offset:34816
    s_waitcnt vmcnt(6)
    s_barrier
    s_waitcnt lgkmcnt(9)
    v_mfma_f32_16x16x32_bf16 v[148:151], v[128:131], v[56:59], v[148:151]
    ds_read_b128 v[108:111], v251 offset:40960
    s_add_u32 m0, s9, 8192
    s_nop 0
    buffer_load_dwordx4 v1, s[4:7], s14 offen sc1 lds
    s_add_u32 s14, s14, 8192
    s_waitcnt lgkmcnt(9)
    v_mfma_f32_16x16x32_bf16 v[152:155], v[132:135], v[56:59], v[152:155]
    ds_read_b128 v[112:115], v251 offset:41984
    s_waitcnt lgkmcnt(9)
    v_mfma_f32_16x16x32_bf16 v[156:159], v[136:139], v[56:59], v[156:159]
    ds_read_b128 v[116:119], v251 offset:43008
    buffer_load_dwordx4 v[48:51], v1, s[4:7], s12 offen offset:2048 sc1
    s_waitcnt lgkmcnt(9)
    v_mfma_f32_16x16x32_bf16 v[160:163], v[140:143], v[56:59], v[160:163]
    ds_read_b128 v[120:123], v251 offset:44032
    s_waitcnt lgkmcnt(9)
    v_mfma_f32_16x16x32_bf16 v[164:167], v[144:147], v[56:59], v[164:167]
    ds_read_b128 v[124:127], v251 offset:45056
    s_waitcnt vmcnt(7)
    s_barrier
    s_waitcnt lgkmcnt(9)
    v_mfma_f32_16x16x32_bf16 v[148:151], v[88:91], v[60:63], v[148:151]
    ds_read_b128 v[128:131], v251 offset:51200
    s_add_u32 m0, s9, 16384
    s_nop 0
    buffer_load_dwordx4 v1, s[4:7], s14 offen sc1 lds
    s_add_u32 s14, s14, 8192
    s_waitcnt lgkmcnt(9)
    v_mfma_f32_16x16x32_bf16 v[152:155], v[92:95], v[60:63], v[152:155]
    ds_read_b128 v[132:135], v251 offset:52224
    s_waitcnt lgkmcnt(9)
    v_mfma_f32_16x16x32_bf16 v[156:159], v[96:99], v[60:63], v[156:159]
    ds_read_b128 v[136:139], v251 offset:53248
    buffer_load_dwordx4 v[52:55], v1, s[4:7], s12 offen offset:3072 sc1
    s_add_u32 s12, s12, 4096
    s_waitcnt lgkmcnt(9)
    v_mfma_f32_16x16x32_bf16 v[160:163], v[100:103], v[60:63], v[160:163]
    ds_read_b128 v[140:143], v251 offset:54272
    s_waitcnt lgkmcnt(9)
    v_mfma_f32_16x16x32_bf16 v[164:167], v[104:107], v[60:63], v[164:167]
    ds_read_b128 v[144:147], v251 offset:55296
    s_waitcnt vmcnt(8)
    s_barrier
    s_waitcnt lgkmcnt(9)
    v_mfma_f32_16x16x32_bf16 v[148:151], v[108:111], v[64:67], v[148:151]
    ds_read_b128 v[88:91], v251 offset:61440
    s_add_u32 m0, s9, 24576
    s_nop 0
    buffer_load_dwordx4 v1, s[4:7], s14 offen sc1 lds
    s_add_u32 s14, s14, 8192
    s_waitcnt lgkmcnt(9)
    v_mfma_f32_16x16x32_bf16 v[152:155], v[112:115], v[64:67], v[152:155]
    ds_read_b128 v[92:95], v251 offset:62464
    s_add_u32 m0, s9, 32768
    s_nop 0
    buffer_load_dwordx4 v1, s[4:7], s14 offen sc1 lds
    s_add_u32 s14, s14, 8192
    s_waitcnt lgkmcnt(9)
    v_mfma_f32_16x16x32_bf16 v[156:159], v[116:119], v[64:67], v[156:159]
    ds_read_b128 v[96:99], v251 offset:63488
    s_waitcnt lgkmcnt(9)
    v_mfma_f32_16x16x32_bf16 v[160:163], v[120:123], v[64:67], v[160:163]
    ds_read_b128 v[100:103], v251 offset:64512
    buffer_load_dwordx4 v[56:59], v1, s[4:7], s12 offen offset:0 sc1
    s_waitcnt lgkmcnt(9)
    v_mfma_f32_16x16x32_bf16 v[164:167], v[124:127], v[64:67], v[164:167]
    ds_read_b128 v[104:107], v252 offset:0
    s_waitcnt vmcnt(10)
    s_barrier
    s_waitcnt lgkmcnt(9)
    v_mfma_f32_16x16x32_bf16 v[148:151], v[128:131], v[68:71], v[148:151]
    ds_read_b128 v[108:111], v252 offset:6144
    s_add_u32 m0, s9, 40960
    s_nop 0
    buffer_load_dwordx4 v1, s[4:7], s14 offen sc1 lds
    s_add_u32 s14, s14, 8192
    s_waitcnt lgkmcnt(9)
    v_mfma_f32_16x16x32_bf16 v[152:155], v[132:135], v[68:71], v[152:155]
    ds_read_b128 v[112:115], v252 offset:7168
    s_waitcnt lgkmcnt(9)
    v_mfma_f32_16x16x32_bf16 v[156:159], v[136:139], v[68:71], v[156:159]
    ds_read_b128 v[116:119], v252 offset:8192
    buffer_load_dwordx4 v[60:63], v1, s[4:7], s12 offen offset:1024 sc1
    s_waitcnt lgkmcnt(9)
    v_mfma_f32_16x16x32_bf16 v[160:163], v[140:143], v[68:71], v[160:163]
    ds_read_b128 v[120:123], v252 offset:9216
    s_waitcnt lgkmcnt(9)
    v_mfma_f32_16x16x32_bf16 v[164:167], v[144:147], v[68:71], v[164:167]
    ds_read_b128 v[124:127], v252 offset:10240
    s_waitcnt vmcnt(10)
    s_barrier
    s_waitcnt lgkmcnt(9)
    v_mfma_f32_16x16x32_bf16 v[148:151], v[88:91], v[72:75], v[148:151]
    ds_read_b128 v[128:131], v252 offset:16384
    s_add_u32 m0, s9, 49152
    s_nop 0
    buffer_load_dwordx4 v1, s[4:7], s14 offen sc1 lds
    s_add_u32 s14, s14, 8192
    s_waitcnt lgkmcnt(9)
    v_mfma_f32_16x16x32_bf16 v[152:155], v[92:95], v[72:75], v[152:155]
    ds_read_b128 v[132:135], v252 offset:17408
    s_waitcnt lgkmcnt(9)
    v_mfma_f32_16x16x32_bf16 v[156:159], v[96:99], v[72:75], v[156:159]
    ds_read_b128 v[136:139], v252 offset:18432
    buffer_load_dwordx4 v[64:67], v1, s[4:7], s12 offen offset:2048 sc1
    s_waitcnt lgkmcnt(9)
    v_mfma_f32_16x16x32_bf16 v[160:163], v[100:103], v[72:75], v[160:163]
    ds_read_b128 v[140:143], v252 offset:19456
    s_waitcnt lgkmcnt(9)
    v_mfma_f32_16x16x32_bf16 v[164:167], v[104:107], v[72:75], v[164:167]
    ds_read_b128 v[144:147], v252 offset:20480
    s_waitcnt vmcnt(11)
    s_barrier
    s_waitcnt lgkmcnt(9)
    v_mfma_f32_16x16x32_bf16 v[148:151], v[108:111], v[76:79], v[148:151]
    ds_read_b128 v[88:91], v252 offset:26624
    s_add_u32 m0, s9, 57344
    s_nop 0
    buffer_load_dwordx4 v1, s[4:7], s14 offen sc1 lds
    s_add_u32 s14, s14, 8192
    s_waitcnt lgkmcnt(9)
    v_mfma_f32_16x16x32_bf16 v[152:155], v[112:115], v[76:79], v[152:155]
    ds_read_b128 v[92:95], v252 offset:27648
    s_waitcnt lgkmcnt(9)
    v_mfma_f32_16x16x32_bf16 v[156:159], v[116:119], v[76:79], v[156:159]
    ds_read_b128 v[96:99], v252 offset:28672
    buffer_load_dwordx4 v[68:71], v1, s[4:7], s12 offen offset:3072 sc1
    s_add_u32 s12, s12, 4096
    s_waitcnt lgkmcnt(9)
    v_mfma_f32_16x16x32_bf16 v[160:163], v[120:123], v[76:79], v[160:163]
    ds_read_b128 v[100:103], v252 offset:29696
    s_waitcnt lgkmcnt(9)
    v_mfma_f32_16x16x32_bf16 v[164:167], v[124:127], v[76:79], v[164:167]
    ds_read_b128 v[104:107], v252 offset:30720
    s_waitcnt vmcnt(11)
    s_barrier
    s_waitcnt lgkmcnt(9)
    v_mfma_f32_16x16x32_bf16 v[148:151], v[128:131], v[80:83], v[148:151]
    ds_read_b128 v[108:111], v252 offset:36864
    s_add_u32 m0, s9, 65536
    s_nop 0
    buffer_load_dwordx4 v1, s[4:7], s14 offen sc1 lds
    s_add_u32 s14, s14, 8192
    s_waitcnt lgkmcnt(9)
    v_mfma_f32_16x16x32_bf16 v[152:155], v[132:135], v[80:83], v[152:155]
    ds_read_b128 v[112:115], v252 offset:37888
    s_add_u32 m0, s9, 73728
    s_nop 0
    buffer_load_dwordx4 v1, s[4:7], s14 offen sc1 lds
    s_add_u32 s14, s14, 8192
    s_waitcnt lgkmcnt(9)
    v_mfma_f32_16x16x32_bf16 v[156:159], v[136:139], v[80:83], v[156:159]
    ds_read_b128 v[116:119], v252 offset:38912
    s_waitcnt lgkmcnt(9)
    v_mfma_f32_16x16x32_bf16 v[160:163], v[140:143], v[80:83], v[160:163]
    ds_read_b128 v[120:123], v252 offset:39936
    buffer_load_dwordx4 v[72:75], v1, s[4:7], s12 offen offset:0 sc1
    s_waitcnt lgkmcnt(9)
    v_mfma_f32_16x16x32_bf16 v[164:167], v[144:147], v[80:83], v[164:167]
    ds_read_b128 v[124:127], v252 offset:40960
    s_waitcnt vmcnt(12)
    s_barrier
    s_waitcnt lgkmcnt(9)
    v_mfma_f32_16x16x32_bf16 v[148:151], v[88:91], v[84:87], v[148:151]
    ds_read_b128 v[128:131], v252 offset:47104
    s_add_u32 m0, s9, 81920
    s_nop 0
    buffer_load_dwordx4 v1, s[4:7], s14 offen sc1 lds
    s_add_u32 s14, s14, 8192
    s_waitcnt lgkmcnt(9)
    v_mfma_f32_16x16x32_bf16 v[152:155], v[92:95], v[84:87], v[152:155]
    ds_read_b128 v[132:135], v252 offset:48128
    s_waitcnt lgkmcnt(9)
    v_mfma_f32_16x16x32_bf16 v[156:159], v[96:99], v[84:87], v[156:159]
    ds_read_b128 v[136:139], v252 offset:49152
    buffer_load_dwordx4 v[76:79], v1, s[4:7], s12 offen offset:1024 sc1
    s_waitcnt lgkmcnt(9)
    v_mfma_f32_16x16x32_bf16 v[160:163], v[100:103], v[84:87], v[160:163]
    ds_read_b128 v[140:143], v252 offset:50176
    s_waitcnt lgkmcnt(9)
    v_mfma_f32_16x16x32_bf16 v[164:167], v[104:107], v[84:87], v[164:167]
    ds_read_b128 v[144:147], v252 offset:51200
    s_waitcnt vmcnt(11)
    s_barrier
    s_waitcnt lgkmcnt(9)
    v_mfma_f32_16x16x32_bf16 v[148:151], v[108:111], v[48:51], v[148:151]
    ds_read_b128 v[88:91], v251 offset:0
    s_add_u32 m0, s9, 90112
    s_nop 0
    buffer_load_dwordx4 v1, s[4:7], s14 offen sc1 lds
    s_add_u32 s14, s14, 8192
    s_waitcnt lgkmcnt(9)
    v_mfma_f32_16x16x32_bf16 v[152:155], v[112:115], v[48:51], v[152:155]
    ds_read_b128 v[92:95], v251 offset:1024
    s_waitcnt lgkmcnt(9)
    v_mfma_f32_16x16x32_bf16 v[156:159], v[116:119], v[48:51], v[156:159]
    ds_read_b128 v[96:99], v251 offset:2048
    buffer_load_dwordx4 v[80:83], v1, s[4:7], s12 offen offset:2048 sc1
    s_waitcnt lgkmcnt(9)
    v_mfma_f32_16x16x32_bf16 v[160:163], v[120:123], v[48:51], v[160:163]
    ds_read_b128 v[100:103], v251 offset:3072
    s_waitcnt lgkmcnt(9)
    v_mfma_f32_16x16x32_bf16 v[164:167], v[124:127], v[48:51], v[164:167]
    ds_read_b128 v[104:107], v251 offset:4096
    s_waitcnt vmcnt(11)
    s_barrier
    s_waitcnt lgkmcnt(9)
    v_mfma_f32_16x16x32_bf16 v[148:151], v[128:131], v[52:55], v[148:151]
    ds_read_b128 v[108:111], v251 offset:10240
    s_add_u32 m0, s9, 98304
    s_nop 0
    buffer_load_dwordx4 v1, s[4:7], s14 offen sc1 lds
    s_add_u32 s14, s14, 8192
    s_waitcnt lgkmcnt(9)
    v_mfma_f32_16x16x32_bf16 v[152:155], v[132:135], v[52:55], v[152:155]
    ds_read_b128 v[112:115], v251 offset:11264
    s_waitcnt lgkmcnt(9)
    v_mfma_f32_16x16x32_bf16 v[156:159], v[136:139], v[52:55], v[156:159]
    ds_read_b128 v[116:119], v251 offset:12288
    buffer_load_dwordx4 v[84:87], v1, s[4:7], s12 offen offset:3072 sc1
    s_add_u32 s12, s12, 4096
    s_waitcnt lgkmcnt(9)
    v_mfma_f32_16x16x32_bf16 v[160:163], v[140:143], v[52:55], v[160:163]
    ds_read_b128 v[120:123], v251 offset:13312
    s_waitcnt lgkmcnt(9)
    v_mfma_f32_16x16x32_bf16 v[164:167], v[144:147], v[52:55], v[164:167]
    ds_read_b128 v[124:127], v251 offset:14336
    s_waitcnt vmcnt(11)
    s_barrier
    s_waitcnt lgkmcnt(9)
    v_mfma_f32_16x16x32_bf16 v[148:151], v[88:91], v[56:59], v[148:151]
    ds_read_b128 v[128:131], v251 offset:20480
    s_add_u32 m0, s9, 106496
    s_nop 0
    buffer_load_dwordx4 v1, s[4:7], s14 offen sc1 lds
    s_add_u32 s14, s14, 8192
    s_waitcnt lgkmcnt(9)
    v_mfma_f32_16x16x32_bf16 v[152:155], v[92:95], v[56:59], v[152:155]
    ds_read_b128 v[132:135], v251 offset:21504
    s_add_u32 m0, s9, 114688
    s_nop 0
    buffer_load_dwordx4 v1, s[4:7], s14 offen sc1 lds
    s_add_u32 s14, s14, 8192
    s_waitcnt lgkmcnt(9)
    v_mfma_f32_16x16x32_bf16 v[156:159], v[96:99], v[56:59], v[156:159]
    ds_read_b128 v[136:139], v251 offset:22528
    s_waitcnt lgkmcnt(9)
    v_mfma_f32_16x16x32_bf16 v[160:163], v[100:103], v[56:59], v[160:163]
    ds_read_b128 v[140:143], v251 offset:23552
    buffer_load_dwordx4 v[48:51], v1, s[4:7], s12 offen offset:0 sc1
    s_waitcnt lgkmcnt(9)
    v_mfma_f32_16x16x32_bf16 v[164:167], v[104:107], v[56:59], v[164:167]
    ds_read_b128 v[144:147], v251 offset:24576
    s_waitcnt vmcnt(12)
    s_barrier
    s_waitcnt lgkmcnt(9)
    v_mfma_f32_16x16x32_bf16 v[148:151], v[108:111], v[60:63], v[148:151]
    ds_read_b128 v[88:91], v251 offset:30720
    s_add_u32 m0, s9, 0
    s_nop 0
    buffer_load_dwordx4 v1, s[4:7], s14 offen sc1 lds
    s_add_u32 s14, s14, 8192
    s_waitcnt lgkmcnt(9)
    v_mfma_f32_16x16x32_bf16 v[152:155], v[112:115], v[60:63], v[152:155]
    ds_read_b128 v[92:95], v251 offset:31744
    s_waitcnt lgkmcnt(9)
    v_mfma_f32_16x16x32_bf16 v[156:159], v[116:119], v[60:63], v[156:159]
    ds_read_b128 v[96:99], v251 offset:32768
    buffer_load_dwordx4 v[52:55], v1, s[4:7], s12 offen offset:1024 sc1
    s_waitcnt lgkmcnt(9)
    v_mfma_f32_16x16x32_bf16 v[160:163], v[120:123], v[60:63], v[160:163]
    ds_read_b128 v[100:103], v251 offset:33792
    s_waitcnt lgkmcnt(9)
    v_mfma_f32_16x16x32_bf16 v[164:167], v[124:127], v[60:63], v[164:167]
    ds_read_b128 v[104:107], v251 offset:34816
    s_waitcnt vmcnt(11)
    s_barrier
    s_waitcnt lgkmcnt(9)
    v_mfma_f32_16x16x32_bf16 v[148:151], v[128:131], v[64:67], v[148:151]
    ds_read_b128 v[108:111], v251 offset:40960
    s_add_u32 m0, s9, 8192
    s_nop 0
    buffer_load_dwordx4 v1, s[4:7], s14 offen sc1 lds
    s_add_u32 s14, s14, 8192
    s_waitcnt lgkmcnt(9)
    v_mfma_f32_16x16x32_bf16 v[152:155], v[132:135], v[64:67], v[152:155]
    ds_read_b128 v[112:115], v251 offset:41984
    s_waitcnt lgkmcnt(9)
    v_mfma_f32_16x16x32_bf16 v[156:159], v[136:139], v[64:67], v[156:159]
    ds_read_b128 v[116:119], v251 offset:43008
    buffer_load_dwordx4 v[56:59], v1, s[4:7], s12 offen offset:2048 sc1
    s_waitcnt lgkmcnt(9)
    v_mfma_f32_16x16x32_bf16 v[160:163], v[140:143], v[64:67], v[160:163]
    ds_read_b128 v[120:123], v251 offset:44032
    s_waitcnt lgkmcnt(9)
    v_mfma_f32_16x16x32_bf16 v[164:167], v[144:147], v[64:67], v[164:167]
    ds_read_b128 v[124:127], v251 offset:45056
    s_waitcnt vmcnt(11)
    s_barrier
    s_waitcnt lgkmcnt(9)
    v_mfma_f32_16x16x32_bf16 v[148:151], v[88:91], v[68:71], v[148:151]
    ds_read_b128 v[128:131], v251 offset:51200
    s_add_u32 m0, s9, 16384
    s_nop 0
    buffer_load_dwordx4 v1, s[4:7], s14 offen sc1 lds
    s_add_u32 s14, s14, 8192
    s_waitcnt lgkmcnt(9)
    v_mfma_f32_16x16x32_bf16 v[152:155], v[92:95], v[68:71], v[152:155]
    ds_read_b128 v[132:135], v251 offset:52224
    s_waitcnt lgkmcnt(9)
    v_mfma_f32_16x16x32_bf16 v[156:159], v[96:99], v[68:71], v[156:159]
    ds_read_b128 v[136:139], v251 offset:53248
    buffer_load_dwordx4 v[60:63], v1, s[4:7], s12 offen offset:3072 sc1
    s_add_u32 s12, s12, 4096
    s_waitcnt lgkmcnt(9)
    v_mfma_f32_16x16x32_bf16 v[160:163], v[100:103], v[68:71], v[160:163]
    ds_read_b128 v[140:143], v251 offset:54272
    s_waitcnt lgkmcnt(9)
    v_mfma_f32_16x16x32_bf16 v[164:167], v[104:107], v[68:71], v[164:167]
    ds_read_b128 v[144:147], v251 offset:55296
    s_waitcnt vmcnt(11)
    s_barrier
    s_waitcnt lgkmcnt(9)
    v_mfma_f32_16x16x32_bf16 v[148:151], v[108:111], v[72:75], v[148:151]
    ds_read_b128 v[88:91], v251 offset:61440
    s_add_u32 m0, s9, 24576
    s_nop 0
    buffer_load_dwordx4 v1, s[4:7], s14 offen sc1 lds
    s_add_u32 s14, s14, 8192
    s_waitcnt lgkmcnt(9)
    v_mfma_f32_16x16x32_bf16 v[152:155], v[112:115], v[72:75], v[152:155]
    ds_read_b128 v[92:95], v251 offset:62464
    s_waitcnt lgkmcnt(9)
    v_mfma_f32_16x16x32_bf16 v[156:159], v[116:119], v[72:75], v[156:159]
    ds_read_b128 v[96:99], v251 offset:63488
    buffer_load_dwordx4 v[64:67], v1, s[4:7], s12 offen offset:0 sc1
    s_waitcnt lgkmcnt(9)
    v_mfma_f32_16x16x32_bf16 v[160:163], v[120:123], v[72:75], v[160:163]
    ds_read_b128 v[100:103], v251 offset:64512
    s_waitcnt lgkmcnt(9)
    v_mfma_f32_16x16x32_bf16 v[164:167], v[124:127], v[72:75], v[164:167]
    ds_read_b128 v[104:107], v252 offset:0
    s_waitcnt vmcnt(11)
    s_waitcnt lgkmcnt(9)
    v_mfma_f32_16x16x32_bf16 v[148:151], v[128:131], v[76:79], v[148:151]
    ds_read_b128 v[108:111], v252 offset:6144
    buffer_load_dwordx4 v[68:71], v1, s[4:7], s12 offen offset:1024 sc1
    s_waitcnt lgkmcnt(9)
    v_mfma_f32_16x16x32_bf16 v[152:155], v[132:135], v[76:79], v[152:155]
    ds_read_b128 v[112:115], v252 offset:7168
    s_waitcnt lgkmcnt(9)
    v_mfma_f32_16x16x32_bf16 v[156:159], v[136:139], v[76:79], v[156:159]
    ds_read_b128 v[116:119], v252 offset:8192
    s_waitcnt lgkmcnt(9)
    v_mfma_f32_16x16x32_bf16 v[160:163], v[140:143], v[76:79], v[160:163]
    ds_read_b128 v[120:123], v252 offset:9216
    s_waitcnt lgkmcnt(9)
    v_mfma_f32_16x16x32_bf16 v[164:167], v[144:147], v[76:79], v[164:167]
    ds_read_b128 v[124:127], v252 offset:10240
    s_waitcnt vmcnt(9)
    s_waitcnt lgkmcnt(9)
    v_mfma_f32_16x16x32_bf16 v[148:151], v[88:91], v[80:83], v[148:151]
    ds_read_b128 v[128:131], v252 offset:16384
    buffer_load_dwordx4 v[72:75], v1, s[4:7], s12 offen offset:2048 sc1
    s_waitcnt lgkmcnt(9)
    v_mfma_f32_16x16x32_bf16 v[152:155], v[92:95], v[80:83], v[152:155]
    ds_read_b128 v[132:135], v252 offset:17408
    s_waitcnt lgkmcnt(9)
    v_mfma_f32_16x16x32_bf16 v[156:159], v[96:99], v[80:83], v[156:159]
    ds_read_b128 v[136:139], v252 offset:18432
    s_waitcnt lgkmcnt(9)
    v_mfma_f32_16x16x32_bf16 v[160:163], v[100:103], v[80:83], v[160:163]
    ds_read_b128 v[140:143], v252 offset:19456
    s_waitcnt lgkmcnt(9)
    v_mfma_f32_16x16x32_bf16 v[164:167], v[104:107], v[80:83], v[164:167]
    ds_read_b128 v[144:147], v252 offset:20480
    s_waitcnt vmcnt(8)
    s_barrier
    s_waitcnt lgkmcnt(9)
    v_mfma_f32_16x16x32_bf16 v[148:151], v[108:111], v[84:87], v[148:151]
    ds_read_b128 v[88:91], v252 offset:26624
    s_waitcnt lgkmcnt(9)
    v_mfma_f32_16x16x32_bf16 v[152:155], v[112:115], v[84:87], v[152:155]
    ds_read_b128 v[92:95], v252 offset:27648
    s_waitcnt lgkmcnt(9)
    v_mfma_f32_16x16x32_bf16 v[156:159], v[116:119], v[84:87], v[156:159]
    ds_read_b128 v[96:99], v252 offset:28672
    s_waitcnt lgkmcnt(9)
    v_mfma_f32_16x16x32_bf16 v[160:163], v[120:123], v[84:87], v[160:163]
    ds_read_b128 v[100:103], v252 offset:29696
    s_waitcnt lgkmcnt(9)
    v_mfma_f32_16x16x32_bf16 v[164:167], v[124:127], v[84:87], v[164:167]
    ds_read_b128 v[104:107], v252 offset:30720
    s_waitcnt vmcnt(6)
    s_waitcnt lgkmcnt(9)
    v_mfma_f32_16x16x32_bf16 v[148:151], v[128:131], v[48:51], v[148:151]
    ds_read_b128 v[108:111], v252 offset:36864
    s_waitcnt lgkmcnt(9)
    v_mfma_f32_16x16x32_bf16 v[152:155], v[132:135], v[48:51], v[152:155]
    ds_read_b128 v[112:115], v252 offset:37888
    s_waitcnt lgkmcnt(9)
    v_mfma_f32_16x16x32_bf16 v[156:159], v[136:139], v[48:51], v[156:159]
    ds_read_b128 v[116:119], v252 offset:38912
    s_waitcnt lgkmcnt(9)
    v_mfma_f32_16x16x32_bf16 v[160:163], v[140:143], v[48:51], v[160:163]
    ds_read_b128 v[120:123], v252 offset:39936
    s_waitcnt lgkmcnt(9)
    v_mfma_f32_16x16x32_bf16 v[164:167], v[144:147], v[48:51], v[164:167]
    ds_read_b128 v[124:127], v252 offset:40960
    s_waitcnt vmcnt(4)
    s_waitcnt lgkmcnt(9)
    v_mfma_f32_16x16x32_bf16 v[148:151], v[88:91], v[52:55], v[148:151]
    ds_read_b128 v[128:131], v252 offset:47104
    s_waitcnt lgkmcnt(9)
    v_mfma_f32_16x16x32_bf16 v[152:155], v[92:95], v[52:55], v[152:155]
    ds_read_b128 v[132:135], v252 offset:48128
    s_waitcnt lgkmcnt(9)
    v_mfma_f32_16x16x32_bf16 v[156:159], v[96:99], v[52:55], v[156:159]
    ds_read_b128 v[136:139], v252 offset:49152
    s_waitcnt lgkmcnt(9)
    v_mfma_f32_16x16x32_bf16 v[160:163], v[100:103], v[52:55], v[160:163]
    ds_read_b128 v[140:143], v252 offset:50176
    s_waitcnt lgkmcnt(9)
    v_mfma_f32_16x16x32_bf16 v[164:167], v[104:107], v[52:55], v[164:167]
    ds_read_b128 v[144:147], v252 offset:51200
    s_waitcnt vmcnt(2)
    s_barrier
    s_waitcnt lgkmcnt(9)
    v_mfma_f32_16x16x32_bf16 v[148:151], v[108:111], v[56:59], v[148:151]
    ds_read_b128 v[88:91], v251 offset:0
    s_waitcnt lgkmcnt(9)
    v_mfma_f32_16x16x32_bf16 v[152:155], v[112:115], v[56:59], v[152:155]
    ds_read_b128 v[92:95], v251 offset:1024
    s_waitcnt lgkmcnt(9)
    v_mfma_f32_16x16x32_bf16 v[156:159], v[116:119], v[56:59], v[156:159]
    ds_read_b128 v[96:99], v251 offset:2048
    s_waitcnt lgkmcnt(9)
    v_mfma_f32_16x16x32_bf16 v[160:163], v[120:123], v[56:59], v[160:163]
    ds_read_b128 v[100:103], v251 offset:3072
    s_waitcnt lgkmcnt(9)
    v_mfma_f32_16x16x32_bf16 v[164:167], v[124:127], v[56:59], v[164:167]
    ds_read_b128 v[104:107], v251 offset:4096
    s_waitcnt vmcnt(1)
    s_waitcnt lgkmcnt(9)
    v_mfma_f32_16x16x32_bf16 v[148:151], v[128:131], v[60:63], v[148:151]
    ds_read_b128 v[108:111], v251 offset:10240
    s_waitcnt lgkmcnt(9)
    v_mfma_f32_16x16x32_bf16 v[152:155], v[132:135], v[60:63], v[152:155]
    ds_read_b128 v[112:115], v251 offset:11264
    s_waitcnt lgkmcnt(9)
    v_mfma_f32_16x16x32_bf16 v[156:159], v[136:139], v[60:63], v[156:159]
    ds_read_b128 v[116:119], v251 offset:12288
    s_waitcnt lgkmcnt(9)
    v_mfma_f32_16x16x32_bf16 v[160:163], v[140:143], v[60:63], v[160:163]
    ds_read_b128 v[120:123], v251 offset:13312
    s_waitcnt lgkmcnt(9)
    v_mfma_f32_16x16x32_bf16 v[164:167], v[144:147], v[60:63], v[164:167]
    ds_read_b128 v[124:127], v251 offset:14336
    s_waitcnt vmcnt(0)
    s_waitcnt lgkmcnt(9)
    v_mfma_f32_16x16x32_bf16 v[148:151], v[88:91], v[64:67], v[148:151]
    ds_read_b128 v[128:131], v251 offset:20480
    s_waitcnt lgkmcnt(9)
    v_mfma_f32_16x16x32_bf16 v[152:155], v[92:95], v[64:67], v[152:155]
    ds_read_b128 v[132:135], v251 offset:21504
    s_waitcnt lgkmcnt(9)
    v_mfma_f32_16x16x32_bf16 v[156:159], v[96:99], v[64:67], v[156:159]
    ds_read_b128 v[136:139], v251 offset:22528
    s_waitcnt lgkmcnt(9)
    v_mfma_f32_16x16x32_bf16 v[160:163], v[100:103], v[64:67], v[160:163]
    ds_read_b128 v[140:143], v251 offset:23552
    s_waitcnt lgkmcnt(9)
    v_mfma_f32_16x16x32_bf16 v[164:167], v[104:107], v[64:67], v[164:167]
    ds_read_b128 v[144:147], v251 offset:24576
    s_waitcnt lgkmcnt(9)
    v_mfma_f32_16x16x32_bf16 v[148:151], v[108:111], v[68:71], v[148:151]
    s_waitcnt lgkmcnt(8)
    v_mfma_f32_16x16x32_bf16 v[152:155], v[112:115], v[68:71], v[152:155]
    s_waitcnt lgkmcnt(7)
    v_mfma_f32_16x16x32_bf16 v[156:159], v[116:119], v[68:71], v[156:159]
    s_waitcnt lgkmcnt(6)
    v_mfma_f32_16x16x32_bf16 v[160:163], v[120:123], v[68:71], v[160:163]
    s_waitcnt lgkmcnt(5)
    v_mfma_f32_16x16x32_bf16 v[164:167], v[124:127], v[68:71], v[164:167]
    s_waitcnt lgkmcnt(4)
    v_mfma_f32_16x16x32_bf16 v[148:151], v[128:131], v[72:75], v[148:151]
    s_waitcnt lgkmcnt(3)
    v_mfma_f32_16x16x32_bf16 v[152:155], v[132:135], v[72:75], v[152:155]
    s_waitcnt lgkmcnt(2)
    v_mfma_f32_16x16x32_bf16 v[156:159], v[136:139], v[72:75], v[156:159]
    s_waitcnt lgkmcnt(1)
    v_mfma_f32_16x16x32_bf16 v[160:163], v[140:143], v[72:75], v[160:163]
    s_waitcnt lgkmcnt(0)
    v_mfma_f32_16x16x32_bf16 v[164:167], v[144:147], v[72:75], v[164:167]
    s_mul_i32 s17, s53, 5120
    s_add_u32 s17, s17, 122880
    v_add_u32 v5, s17, v1
    v_lshlrev_b32 v6, 5, v241
    v_add_u32 v6, 160064, v6
    v_lshlrev_b32 v7, 4, v241
    v_add_u32 v7, 160320, v7
    s_cmp_eq_u32 s52, 0
    s_nop 0
    s_cbranch_scc1 Lwk1_26
    ds_write_b128 v5, v[148:151] offset:0
    ds_write_b128 v5, v[152:155] offset:1024
    ds_write_b128 v5, v[156:159] offset:2048
    ds_write_b128 v5, v[160:163] offset:3072
    ds_write_b128 v5, v[164:167] offset:4096
Lwk1_26:
    ds_read_b128 v[20:23], v6 offset:0
    ds_read_b128 v[24:27], v6 offset:16
    ds_read_b128 v[28:31], v6 offset:128
    ds_read_b128 v[32:35], v6 offset:144
    ds_read_b128 v[36:39], v7
    s_waitcnt lgkmcnt(0)
    s_barrier
    s_cmp_eq_u32 s52, 1
    s_cbranch_scc1 LM_end
    ds_read_b128 v[68:71], v5 offset:0
    ds_read_b128 v[72:75], v5 offset:1024
    ds_read_b128 v[76:79], v5 offset:2048
    ds_read_b128 v[80:83], v5 offset:3072
    ds_read_b128 v[84:87], v5 offset:4096
    v_lshlrev_b32 v48, 16, v8
    v_and_b32 v49, 0xffff0000, v8
    v_lshlrev_b32 v50, 16, v9
    v_and_b32 v51, 0xffff0000, v9
    v_lshlrev_b32 v52, 16, v10
    v_and_b32 v53, 0xffff0000, v10
    v_lshlrev_b32 v54, 16, v11
    v_and_b32 v55, 0xffff0000, v11
    v_lshlrev_b32 v56, 16, v12
    v_and_b32 v57, 0xffff0000, v12
    v_lshlrev_b32 v58, 16, v13
    v_and_b32 v59, 0xffff0000, v13
    v_lshlrev_b32 v60, 16, v14
    v_and_b32 v61, 0xffff0000, v14
    v_lshlrev_b32 v62, 16, v15
    v_and_b32 v63, 0xffff0000, v15
    v_lshlrev_b32 v64, 16, v16
    v_and_b32 v65, 0xffff0000, v16
    v_lshlrev_b32 v66, 16, v17
    v_and_b32 v67, 0xffff0000, v17
    s_waitcnt lgkmcnt(4)
    v_pk_add_f32 v[148:149], v[148:149], v[68:69]
    v_pk_add_f32 v[150:151], v[150:151], v[70:71]
    s_waitcnt lgkmcnt(3)
    v_pk_add_f32 v[152:153], v[152:153], v[72:73]
    v_pk_add_f32 v[154:155], v[154:155], v[74:75]
    s_waitcnt lgkmcnt(2)
    v_pk_add_f32 v[156:157], v[156:157], v[76:77]
    v_pk_add_f32 v[158:159], v[158:159], v[78:79]
    s_waitcnt lgkmcnt(1)
    v_pk_add_f32 v[160:161], v[160:161], v[80:81]
    v_pk_add_f32 v[162:163], v[162:163], v[82:83]
    s_waitcnt lgkmcnt(0)
    v_pk_add_f32 v[164:165], v[164:165], v[84:85]
    v_pk_add_f32 v[166:167], v[166:167], v[86:87]
    v_pk_fma_f32 v[48:49], v[148:149], v[20:21], v[48:49]
    v_pk_fma_f32 v[50:51], v[150:151], v[22:23], v[50:51]
    v_pk_fma_f32 v[52:53], v[152:153], v[24:25], v[52:53]
    v_pk_fma_f32 v[54:55], v[154:155], v[26:27], v[54:55]
    v_pk_fma_f32 v[56:57], v[156:157], v[28:29], v[56:57]
    v_pk_fma_f32 v[58:59], v[158:159], v[30:31], v[58:59]
    v_pk_fma_f32 v[60:61], v[160:161], v[32:33], v[60:61]
    v_pk_fma_f32 v[62:63], v[162:163], v[34:35], v[62:63]
    v_pk_fma_f32 v[64:65], v[164:165], v[36:37], v[64:65]
    v_pk_fma_f32 v[66:67], v[166:167], v[38:39], v[66:67]
    v_cvt_pk_bf16_f32 v8, v48, v49
    v_cvt_pk_bf16_f32 v9, v50, v51
    v_cvt_pk_bf16_f32 v10, v52, v53
    v_cvt_pk_bf16_f32 v11, v54, v55
    v_cvt_pk_bf16_f32 v12, v56, v57
    v_cvt_pk_bf16_f32 v13, v58, v59
    v_cvt_pk_bf16_f32 v14, v60, v61
    v_cvt_pk_bf16_f32 v15, v62, v63
    v_cvt_pk_bf16_f32 v16, v64, v65
    v_cvt_pk_bf16_f32 v17, v66, v67
    buffer_store_dwordx4 v[8:11], v246, s[36:39], s59 offen
    buffer_store_dwordx4 v[12:15], v246, s[36:39], s59 offen offset:64
    buffer_store_dwordx2 v[16:17], v247, s[36:39], s59 offen offset:128
    s_nop 0
LM_end:
    s_endpgm
.section .rodata,"a"
.p2align 6
.amdhsa_kernel k1_kernel
  .amdhsa_next_free_vgpr 128
  .amdhsa_next_free_sgpr 58
  .amdhsa_accum_offset 128
  .amdhsa_group_segment_fixed_size 0
  .amdhsa_kernarg_size 104
  .amdhsa_user_sgpr_count 2
  .amdhsa_user_sgpr_kernarg_segment_ptr 1
  .amdhsa_system_sgpr_workgroup_id_x 1
.end_amdhsa_kernel
.p2align 6
.amdhsa_kernel mega_kernel
  .amdhsa_next_free_vgpr 256
  .amdhsa_next_free_sgpr 69
  .amdhsa_accum_offset 256
  .amdhsa_group_segment_fixed_size 0
  .amdhsa_kernarg_size 104
  .amdhsa_user_sgpr_count 2
  .amdhsa_user_sgpr_kernarg_segment_ptr 1
  .amdhsa_system_sgpr_workgroup_id_x 1
.end_amdhsa_kernel
```
